```python
import torch

def _softmax(x, axis=-1):
    return torch.softmax(x, dim=axis)
def _gelu(x):
    return torch.nn.functional.gelu(x, approximate="tanh")
def _silu(x):
    return torch.nn.functional.silu(x)
def _sigmoid(x):
    return torch.sigmoid(x)
def _layernorm(x, axis=-1, eps=1e-5):
    m = x.mean(dim=axis, keepdim=True)
    v = x.var(dim=axis, keepdim=True, unbiased=False)
    return (x - m) / torch.sqrt(v + eps)
def _scatter_add(tgt, idx, src, axis=0):
    return tgt.clone().index_add_(axis, idx, src)
def _segment_sum(src, seg, n):
    out = torch.zeros((n,) + src.shape[1:], dtype=src.dtype)
    return out.index_add_(0, seg, src)
def _pad(x, pw):
    flat = tuple(v for pair in reversed(pw) for v in pair)
    return torch.nn.functional.pad(x, flat)

kernel_name = 'parallel_sum__mha_block__dense_activation_relu__prompt'

def setup_inputs():

    _w = (lambda a: (lambda t: t.to(torch.bfloat16) if t.is_floating_point() else t)(torch.as_tensor(a)))
    def _A_setup():
        B, S, D, H = 1, 2048, 448, 16
        return {
            "x": _w((lambda *s: torch.randn(*s, dtype=torch.bfloat16) * 0.05)(B, S, D)),
            "wqkv": _w((lambda *s: torch.randn(*s, dtype=torch.bfloat16) * 0.2)(D, 3 * D)),
            "wo": _w((lambda *s: torch.randn(*s, dtype=torch.bfloat16) * 0.1)(D, D)),
        }
    _A_in = _A_setup()

    def _B_setup():
        B, S, D, Dff = 1, 2048, 448, 1792
        return {
            "x": _w((lambda *s: torch.randn(*s, dtype=torch.bfloat16) * 0.05)(B, S, D)),
            "w1": _w((lambda *s: torch.randn(*s, dtype=torch.bfloat16) * 0.2)(D, Dff)),
            "w2": _w((lambda *s: torch.randn(*s, dtype=torch.bfloat16) * 0.2)(Dff, D)),
        }
    _B_in = _B_setup()

    return {
        "A_x": _A_in["x"],
        "A_wqkv": _A_in["wqkv"],
        "A_wo": _A_in["wo"],
        "B_x": _B_in["x"],
        "B_w1": _B_in["w1"],
        "B_w2": _B_in["w2"],
    }

def reference(A_x, A_wqkv, A_wo, B_x, B_w1, B_w2):
    def _A_ref(x, wqkv, wo):
        B, S, D = x.shape
        H = 16
        Dh = D // H
        qkv = (lambda x, *d: x.permute(*d))((x @ wqkv).reshape(B, S, 3, H, Dh), 2, 0, 3, 1, 4)
        q, k, v = qkv[0], qkv[1], qkv[2]
        scores = torch.einsum("bhqd,bhkd->bhqk", q, k) * (Dh ** -0.5)
        p = _softmax(scores, axis=-1)
        o = torch.einsum("bhqk,bhkd->bhqd", p, v)
        return (lambda x, *d: x.permute(*d))(o, 0, 2, 1, 3).reshape(B, S, D) @ wo

    def _B_ref(x, w1, w2):
        h = torch.einsum("bsd,df->bsf", x, w1)
        zero = torch.zeros_like(h)
        h = torch.maximum(h, zero)
        return torch.einsum("bsf,fd->bsd", h, w2)

    x = A_x
    xn = _layernorm(x, axis=-1)
    return x + _A_ref(xn, A_wqkv, A_wo) + _B_ref(xn, B_w1, B_w2)
```

```asm
; @launch grid=(256,1,1) block=(512,1,1) lds=163840
.amdgcn_target "amdgcn-amd-amdhsa--gfx950"
.text
.globl parallel_sum__mha_block__dense_activation_relu__prompt_kernel
.type parallel_sum__mha_block__dense_activation_relu__prompt_kernel,@function
.p2align 8
parallel_sum__mha_block__dense_activation_relu__prompt_kernel:
  s_cmp_ge_u32 s2, 256
  s_cbranch_scc1 k_end

  s_load_dwordx4 s[4:7], s[0:1], 0
  s_load_dwordx2 s[8:9], s[0:1], 16
  s_load_dwordx8 s[12:19], s[0:1], 32
  s_load_dwordx2 s[20:21], s[0:1], 64
  v_lshlrev_b32 v7, 3, v0
  v_add_u32 v7, 159744, v7
  v_mov_b32 v4, 0
  v_mov_b32 v5, 0
  ds_write_b64 v7, v[4:5]
  v_and_b32 v1, 63, v0
  v_lshrrev_b32 v7, 6, v0
  v_lshlrev_b32 v2, 4, v1
  v_readfirstlane_b32 s38, v7
  s_and_b32 s36, s2, 7
  s_lshr_b32 s37, s2, 3
  s_mov_b32 s22, 0x10000000
  s_mov_b32 s23, 0x00020000
  s_mov_b32 s27, 0x00020000
  s_mov_b32 s31, 0x00020000
  s_mov_b32 s35, 0x00020000
  s_and_b32 s39, s38, 3
  s_and_b32 s40, s36, 1
  s_lshl_b32 s40, s40, 3
  s_and_b32 s42, s37, 7
  s_add_u32 s40, s40, s42
  s_lshl_b32 s40, s40, 2
  s_add_u32 s40, s40, s39
  s_lshr_b32 s41, s36, 1
  s_lshl_b32 s41, s41, 2
  s_lshr_b32 s42, s37, 3
  s_add_u32 s41, s41, s42
  v_and_b32 v10, 3, v1
  v_lshlrev_b32 v10, 2, v10
  v_add_u32 v10, 155648, v10
  s_lshl_b32 s42, s39, 2
  s_add_u32 s42, s42, 155648
  v_min_u32 v0, 1, v1
  v_lshlrev_b32 v9, 9, v0
  v_lshl_add_u32 v9, v1, 2, v9
  v_add_u32 v9, s42, v9
  v_lshlrev_b32 v0, 30, v0
  s_cmp_lt_u32 s38, 4
  s_cbranch_scc1 k_comp

  v_lshrrev_b32 v14, 3, v1
  v_lshrrev_b32 v15, 4, v1
  v_and_b32 v16, 7, v1
  v_xor_b32 v16, v16, v15
  v_lshlrev_b32 v16, 4, v16
  s_movk_i32 s42, 896
  v_mad_u32_u24 v7, v14, s42, v16
  v_xor_b32 v8, 64, v7
  s_mul_i32 s46, s40, 28672
  s_lshl_b32 s49, s39, 12
  s_mul_i32 s50, s39, 3072
  s_add_u32 s50, s50, 16384
  s_mul_i32 s47, s39, 43008
  s_mul_i32 s42, s41, 168
  s_and_b32 s42, s42, -16
  s_add_u32 s47, s47, s42
  s_lshr_b32 s42, s37, 3
  s_lshl_b32 s42, s42, 1
  s_and_b32 s52, s37, 7
  s_add_u32 s52, s52, s42
  s_mul_i32 s52, s52, 0
  s_cmp_ge_u32 s52, 7
  s_cselect_b32 s42, 7, 0
  s_sub_u32 s52, s52, s42
  s_mov_b32 s55, s52
  s_lshl_b32 s42, s52, 7
  s_add_u32 s46, s46, s42
  s_mul_i32 s42, s52, 172032
  s_add_u32 s47, s47, s42
  s_movk_i32 s42, 5462
  s_movk_i32 s43, 2688
  v_mov_b32 v18, 0x40000000

  v_add_u32 v14, 0, v1
  v_mul_u32_u24 v16, s42, v14
  v_lshrrev_b32 v16, 16, v16
  v_mul_u32_u24 v17, 12, v16
  v_sub_u32 v14, v14, v17
  v_cmp_eq_u32 vcc, 11, v14
  v_lshlrev_b32 v14, 4, v14
  v_mad_u32_u24 v3, v16, s43, v14
  v_cndmask_b32 v3, v3, v18, vcc

  v_add_u32 v14, 64, v1
  v_mul_u32_u24 v16, s42, v14
  v_lshrrev_b32 v16, 16, v16
  v_mul_u32_u24 v17, 12, v16
  v_sub_u32 v14, v14, v17
  v_cmp_eq_u32 vcc, 11, v14
  v_lshlrev_b32 v14, 4, v14
  v_mad_u32_u24 v4, v16, s43, v14
  v_cndmask_b32 v4, v4, v18, vcc

  v_add_u32 v14, 128, v1
  v_mul_u32_u24 v16, s42, v14
  v_lshrrev_b32 v16, 16, v16
  v_mul_u32_u24 v17, 12, v16
  v_sub_u32 v14, v14, v17
  v_cmp_eq_u32 vcc, 11, v14
  v_lshlrev_b32 v14, 4, v14
  v_mad_u32_u24 v5, v16, s43, v14
  v_cndmask_b32 v5, v5, v18, vcc

  v_mov_b32 v13, 0
  s_mov_b32 s48, 126976
  s_mov_b32 s53, 126976
  s_mov_b32 s45, 0
  s_waitcnt lgkmcnt(0)
  s_barrier

  s_mov_b32 s24, s4
  s_mov_b32 s25, s5
  s_mov_b32 s26, 1835008

  s_mov_b32 s28, s6
  s_mov_b32 s29, s7
  s_mov_b32 s30, 1204224

  s_mov_b32 s32, s12
  s_mov_b32 s33, s13
  s_mov_b32 s34, 1605632

ld_loop:
  s_cmp_lt_u32 s45, 5
  s_cbranch_scc1 ld_isa
  s_sub_u32 s44, s45, 4

  s_waitcnt lgkmcnt(5)
  s_cmp_lt_u32 s45, 9
  s_cbranch_scc1 ld_chk
  s_waitcnt lgkmcnt(1)

ld_chk:
  v_cmp_gt_u32 vcc, s44, v18
  s_cbranch_vccz ld_free

  s_mov_b32 s78, 4194304
lw_1:
  ds_read_b32 v15, v10 offset:6160
  s_waitcnt lgkmcnt(0)
  v_cmp_gt_u32 vcc, s44, v15
  s_cbranch_vccz lwd_2
  s_sleep 1
  s_sub_u32 s78, s78, 1
  s_cbranch_scc0 lw_1

lwd_2:
ld_free:
  s_cmp_ge_u32 s45, 7
  s_cbranch_scc1 ld_isb

ld_isa:
  s_add_u32 m0, s48, s49
  s_add_u32 s42, s46, 0
  buffer_load_dwordx4 v7, s[24:27], s42 offen lds
  s_add_u32 m0, m0, 1024
  s_add_u32 s42, s46, 7168
  buffer_load_dwordx4 v8, s[24:27], s42 offen lds
  s_add_u32 m0, m0, 1024
  s_add_u32 s42, s46, 14336
  buffer_load_dwordx4 v7, s[24:27], s42 offen lds
  s_add_u32 m0, m0, 1024
  s_add_u32 s42, s46, 21504
  buffer_load_dwordx4 v8, s[24:27], s42 offen lds
  s_add_u32 m0, s48, s50
  s_add_u32 s46, s46, 128
  buffer_load_dwordx4 v3, s[28:31], s47 offen lds
  s_add_u32 m0, m0, 1024
  s_nop 0
  buffer_load_dwordx4 v4, s[28:31], s47 offen lds
  s_add_u32 m0, m0, 1024
  s_nop 0
  buffer_load_dwordx4 v5, s[28:31], s47 offen lds
  s_add_u32 s47, s47, 172032
  s_add_u32 s55, s55, 1
  s_cmp_eq_u32 s55, 7
  s_cselect_b32 s42, 896, 0
  s_cselect_b32 s43, 1204224, 0
  s_sub_u32 s46, s46, s42
  s_sub_u32 s47, s47, s43
  s_cmp_lg_u32 s45, 1
  s_cbranch_scc1 ld_post

  v_lshrrev_b32 v15, 4, v1
  v_lshlrev_b32 v17, 2, v15
  v_and_b32 v16, 15, v1
  v_xor_b32 v16, v16, v17
  v_lshlrev_b32 v17, 4, v16
  s_movk_i32 s42, 3584
  v_mad_u32_u24 v13, v15, s42, v17
  s_and_b32 s42, s41, 1
  s_lshl_b32 s42, s42, 2
  v_cmp_gt_u32 vcc, s42, v16
  v_mov_b32 v17, 0x40000000
  s_nop 0
  v_cndmask_b32 v13, v13, v17, vcc
  s_lshr_b32 s42, s41, 1
  s_mul_i32 s51, s42, 448
  s_and_b32 s42, s41, 1
  s_mul_i32 s42, s42, 192
  s_add_u32 s51, s51, s42
  s_mul_i32 s56, s39, 28
  s_lshl_b32 s42, s52, 6
  s_add_u32 s56, s56, s42
  s_mul_i32 s54, s39, 7168
  v_and_b32 v14, 31, v1
  v_lshrrev_b32 v15, 5, v1
  v_bfe_u32 v16, v1, 1, 3
  v_xor_b32 v15, v15, v16
  v_lshlrev_b32 v15, 4, v15
  v_lshl_add_u32 v20, v14, 7, v15
  v_add_u32 v20, s49, v20
  v_mov_b32 v14, 0

  s_branch ld_post
ld_isb:
  s_add_u32 m0, s48, s54
  s_cmp_ge_u32 s56, 448
  s_cselect_b32 s42, 448, 0
  s_sub_u32 s56, s56, s42
  s_mul_i32 s42, s56, 3584
  s_add_u32 s42, s42, s51
  buffer_load_dwordx4 v13, s[32:35], s42 offen lds
  s_add_u32 s56, s56, 4

  s_add_u32 m0, m0, 1024
  s_cmp_ge_u32 s56, 448
  s_cselect_b32 s42, 448, 0
  s_sub_u32 s56, s56, s42
  s_mul_i32 s42, s56, 3584
  s_add_u32 s42, s42, s51
  buffer_load_dwordx4 v13, s[32:35], s42 offen lds
  s_add_u32 s56, s56, 4

  s_add_u32 m0, m0, 1024
  s_cmp_ge_u32 s56, 448
  s_cselect_b32 s42, 448, 0
  s_sub_u32 s56, s56, s42
  s_mul_i32 s42, s56, 3584
  s_add_u32 s42, s42, s51
  buffer_load_dwordx4 v13, s[32:35], s42 offen lds
  s_add_u32 s56, s56, 4

  s_add_u32 m0, m0, 1024
  s_cmp_ge_u32 s56, 448
  s_cselect_b32 s42, 448, 0
  s_sub_u32 s56, s56, s42
  s_mul_i32 s42, s56, 3584
  s_add_u32 s42, s42, s51
  buffer_load_dwordx4 v13, s[32:35], s42 offen lds
  s_add_u32 s56, s56, 4

  s_add_u32 m0, m0, 1024
  s_cmp_ge_u32 s56, 448
  s_cselect_b32 s42, 448, 0
  s_sub_u32 s56, s56, s42
  s_mul_i32 s42, s56, 3584
  s_add_u32 s42, s42, s51
  buffer_load_dwordx4 v13, s[32:35], s42 offen lds
  s_add_u32 s56, s56, 4

  s_add_u32 m0, m0, 1024
  s_cmp_ge_u32 s56, 448
  s_cselect_b32 s42, 448, 0
  s_sub_u32 s56, s56, s42
  s_mul_i32 s42, s56, 3584
  s_add_u32 s42, s42, s51
  buffer_load_dwordx4 v13, s[32:35], s42 offen lds
  s_add_u32 s56, s56, 4

  s_add_u32 m0, m0, 1024
  s_cmp_ge_u32 s56, 448
  s_cselect_b32 s42, 448, 0
  s_sub_u32 s56, s56, s42
  s_mul_i32 s42, s56, 3584
  s_add_u32 s42, s42, s51
  buffer_load_dwordx4 v13, s[32:35], s42 offen lds
  s_add_u32 s56, s56, 88

ld_post:
  s_add_u32 s48, s48, 28672
  s_cmp_ge_u32 s48, 155648
  s_cselect_b32 s48, 12288, s48
  s_cmp_lt_u32 s45, 1
  s_cbranch_scc1 ld_next
  ds_read_b32 v18, v10 offset:6160
  s_sub_u32 s42, s45, 1
  s_add_u32 s43, s42, 1
  v_mov_b32 v14, s43
  v_add_u32 v22, s53, v20
  v_xor_b32 v23, 32, v22
  v_xor_b32 v24, 64, v22
  v_xor_b32 v25, 96, v22
  s_add_u32 s53, s53, 28672
  s_cmp_ge_u32 s53, 155648
  s_cselect_b32 s53, 12288, s53

  s_cmp_lg_u32 s42, 0
  s_cbranch_scc1 ld_sv1
  s_waitcnt vmcnt(7)
  ds_read_b128 v[144:147], v22
  ds_read_b128 v[148:151], v23
  ds_read_b128 v[152:155], v24
  ds_read_b128 v[156:159], v25
  s_branch ld_sig
ld_sv1:
  s_cmp_lg_u32 s42, 1
  s_cbranch_scc1 ld_sv2
  s_waitcnt vmcnt(7)
  ds_read_b128 v[160:163], v22
  ds_read_b128 v[164:167], v23
  ds_read_b128 v[168:171], v24
  ds_read_b128 v[172:175], v25
  s_branch ld_sig
ld_sv2:
  s_cmp_lg_u32 s42, 2
  s_cbranch_scc1 ld_sv3
  s_waitcnt vmcnt(7)
  ds_read_b128 v[176:179], v22
  ds_read_b128 v[180:183], v23
  ds_read_b128 v[184:187], v24
  ds_read_b128 v[188:191], v25
  s_branch ld_sig
ld_sv3:
  s_cmp_lg_u32 s42, 3
  s_cbranch_scc1 ld_sv4
  s_waitcnt vmcnt(7)
  ds_read_b128 v[192:195], v22
  ds_read_b128 v[196:199], v23
  ds_read_b128 v[200:203], v24
  ds_read_b128 v[204:207], v25
  s_branch ld_sig
ld_sv4:
  s_cmp_lg_u32 s42, 4
  s_cbranch_scc1 ld_sv5
  s_waitcnt vmcnt(7)
  ds_read_b128 v[208:211], v22
  ds_read_b128 v[212:215], v23
  ds_read_b128 v[216:219], v24
  ds_read_b128 v[220:223], v25
  s_branch ld_sig
ld_sv5:
  s_cmp_lg_u32 s42, 5
  s_cbranch_scc1 ld_sv6
  s_waitcnt vmcnt(7)
  ds_read_b128 v[224:227], v22
  ds_read_b128 v[228:231], v23
  ds_read_b128 v[232:235], v24
  ds_read_b128 v[236:239], v25
  s_branch ld_sig
ld_sv6:
  s_cmp_lg_u32 s42, 6
  s_cbranch_scc1 ld_sv7
  s_waitcnt vmcnt(7)
  ds_read_b128 v[240:243], v22
  ds_read_b128 v[244:247], v23
  ds_read_b128 v[248:251], v24
  ds_read_b128 v[252:255], v25
  s_branch ld_sig
ld_sv7:
  s_waitcnt vmcnt(7)
ld_sig:
  ds_write_b32 v9, v14 offset:6144
ld_next:
  s_add_u32 s45, s45, 1
  s_cmp_lt_u32 s45, 11
  s_cbranch_scc1 ld_loop

  s_branch c_passb
k_comp:
  s_waitcnt lgkmcnt(0)
  s_barrier

  s_mov_b32 s32, s18
  s_mov_b32 s33, s19
  s_mov_b32 s34, 256

  s_mov_b32 s24, s4
  s_mov_b32 s25, s5
  s_mov_b32 s26, 1835008

  s_mov_b32 s28, s14
  s_mov_b32 s29, s15
  s_mov_b32 s30, 1605632

  s_or_b32 s42, s2, s39
  s_cmp_lg_u32 s42, 0
  s_cbranch_scc1 c_notag
  s_memrealtime s[76:77]
  s_waitcnt lgkmcnt(0)
  s_or_b32 s76, s76, 1
  s_or_b32 s77, s77, 0x40000000
  v_mov_b32 v18, s76
  v_mov_b32 v19, s77
  buffer_store_dwordx2 v[18:19], v0, s[32:35], 0 offen sc1

c_notag:
  v_mov_b32 v17, 0x40000000
  v_lshrrev_b32 v3, 5, v1
  v_bfe_u32 v26, v1, 2, 2
  v_bfe_u32 v27, v1, 4, 1
  v_and_b32 v28, 3, v1
  v_lshlrev_b32 v27, 5, v27
  v_lshl_add_u32 v27, v28, 3, v27
  v_lshl_add_u32 v29, v3, 3, v26
  s_movk_i32 s42, 192
  v_mad_u32_u24 v17, v29, s42, v27
  s_and_b32 s42, s41, 1
  s_lshl_b32 s42, s42, 3
  s_add_u32 s42, s42, 16384
  v_add_u32 v17, s42, v17
  v_mov_b32 v36, 0
  v_mov_b32 v37, 0
  v_mov_b32 v38, 0
  v_mov_b32 v39, 0
  v_and_b32 v30, 31, v1
  v_bfe_u32 v31, v1, 1, 3
  v_xor_b32 v31, v31, v3
  v_lshlrev_b32 v31, 4, v31
  v_mfma_f32_32x32x16_bf16 v[80:95], v[36:39], v[36:39], 0
  v_lshl_add_u32 v7, v30, 7, v31
  s_lshl_b32 s42, s39, 12
  v_add_u32 v7, s42, v7
  v_lshlrev_b32 v35, 4, v3
  v_add_u32 v35, 159744, v35
  v_lshlrev_b32 v16, 8, v29
  v_mfma_f32_32x32x16_bf16 v[96:111], v[36:39], v[36:39], 0
  v_add_u32 v16, v16, v27
  v_lshlrev_b32 v32, 6, v26
  v_or_b32 v16, v16, v32
  v_mfma_f32_32x32x16_bf16 v[112:127], v[36:39], v[36:39], 0
  v_sub_u32 v4, v3, 1
  v_sub_u32 v3, 0, v3
  v_mov_b32 v5, v4
  v_and_b32 v6, 0x3f80, v3
  s_mov_b32 s58, 0x80008000
  s_mov_b32 s61, 0x3f803f80
  s_mov_b32 s45, 1
  s_mov_b32 s60, 126976
  s_mov_b32 s62, 0
  s_mul_i32 s43, s41, 3
  s_cmp_eq_u32 s39, 3
  s_cselect_b32 s44, 0, s39
  v_mov_b32 v25, v17

  s_add_u32 s42, s43, s44
  s_cmp_lt_u32 s42, 16
  s_cselect_b32 s50, 0x3e8b97f6, 1.0
  s_cselect_b32 s62, 11, 12
  s_cselect_b32 s78, 0, 2097152
  s_cmp_ge_u32 s42, 32
  s_cselect_b32 s78, 2099200, s78
  s_and_b32 s42, s42, 15
  s_lshl_b32 s42, s42, 6
  s_add_u32 s42, s42, s40
  s_lshl_b32 s42, s42, s62
  s_add_u32 s46, s42, s78
  s_lshl_b32 s54, s44, 7
  s_mul_i32 s42, s44, 56
  v_add_u32 v17, s42, v25
  s_add_u32 s44, s44, 1
  s_cmp_eq_u32 s44, 3
  s_cselect_b32 s44, 0, s44
  v_add_u32 v21, s60, v17

  s_add_u32 s42, s43, s44
  s_cmp_lt_u32 s42, 16
  s_cselect_b32 s51, 0x3e8b97f6, 1.0
  s_cselect_b32 s62, 11, 12
  s_cselect_b32 s78, 0, 2097152
  s_cmp_ge_u32 s42, 32
  s_cselect_b32 s78, 2099200, s78
  s_and_b32 s42, s42, 15
  s_lshl_b32 s42, s42, 6
  s_add_u32 s42, s42, s40
  s_lshl_b32 s42, s42, s62
  s_add_u32 s47, s42, s78
  s_lshl_b32 s55, s44, 7
  s_mul_i32 s42, s44, 56
  v_add_u32 v18, s42, v25
  s_add_u32 s44, s44, 1
  s_cmp_eq_u32 s44, 3
  s_cselect_b32 s44, 0, s44
  v_add_u32 v22, s60, v18

  s_add_u32 s42, s43, s44
  s_cmp_lt_u32 s42, 16
  s_cselect_b32 s52, 0x3e8b97f6, 1.0
  s_cselect_b32 s62, 11, 12
  s_cselect_b32 s78, 0, 2097152
  s_cmp_ge_u32 s42, 32
  s_cselect_b32 s78, 2099200, s78
  s_and_b32 s42, s42, 15
  s_lshl_b32 s42, s42, 6
  s_add_u32 s42, s42, s40
  s_lshl_b32 s42, s42, s62
  s_add_u32 s48, s42, s78
  s_lshl_b32 s56, s44, 7
  s_mul_i32 s42, s44, 56
  v_add_u32 v19, s42, v25
  s_add_u32 s44, s44, 1
  s_cmp_eq_u32 s44, 3
  s_cselect_b32 s44, 0, s44
  v_add_u32 v23, s60, v19

  s_mov_b32 s57, 0
  s_mov_b32 s59, 1
  v_add_u32 v8, s60, v7
  v_mov_b32 v33, 0
  v_mov_b32 v34, 0
  v_and_b32 v25, 0x13, v1
  v_cmp_ne_u32 vcc, 0x13, v25
  v_and_b32 v26, 7, v1
  v_mul_u32_u24 v26, 768, v26
  v_cndmask_b32 v28, 0, 1, vcc
  v_lshrrev_b32 v27, 1, v1
  v_and_b32 v27, 3, v27
  v_mul_u32_u24 v27, 1536, v27
  v_add_u32 v26, v26, v27
  v_mov_b32 v30, s61
  v_mov_b32 v31, s61
  ds_write_b64 v26, v[30:31]
  v_mul_u32_u24 v18, v28, v18
  v_mad_u32_u24 v22, v28, s60, v18

  v_mov_b32 v29, 0
  v_mov_b32 v30, 0
  v_mov_b32 v31, 0
  v_mov_b32 v32, 0
  s_mov_b32 s78, 4194304
lw_3:
  ds_read_b32 v15, v10 offset:6144
  s_waitcnt lgkmcnt(0)
  v_cmp_gt_u32 vcc, 1, v15
  s_cbranch_vccz lwd_4
  s_sleep 1
  s_sub_u32 s78, s78, 1
  s_cbranch_scc0 lw_3

lwd_4:
  s_setprio 3
  ds_read_b128 v[140:143], v8
  ds_read_b64_tr_b16 v[128:129], v21 offset:0
  ds_read_b64_tr_b16 v[130:131], v21 offset:768
  ds_read_b64_tr_b16 v[132:133], v22 offset:0
  ds_read_b64_tr_b16 v[134:135], v22 offset:768
  ds_read_b64_tr_b16 v[136:137], v23 offset:0
  ds_read_b64_tr_b16 v[138:139], v23 offset:768
  v_xor_b32 v20, 32, v8
  ds_read_b128 v[156:159], v20
  ds_read_b64_tr_b16 v[144:145], v21 offset:3072
  ds_read_b64_tr_b16 v[146:147], v21 offset:3840
  ds_read_b64_tr_b16 v[148:149], v22 offset:3072
  ds_read_b64_tr_b16 v[150:151], v22 offset:3840
  ds_read_b64_tr_b16 v[152:153], v23 offset:3072
  ds_read_b64_tr_b16 v[154:155], v23 offset:3840
  s_waitcnt lgkmcnt(0)
  v_xor_b32 v20, 64, v8
  ds_read_b128 v[172:175], v20
  ds_read_b64_tr_b16 v[160:161], v21 offset:6144
  ds_read_b64_tr_b16 v[162:163], v21 offset:6912
  ds_read_b64_tr_b16 v[164:165], v22 offset:6144
  ds_read_b64_tr_b16 v[166:167], v22 offset:6912
  ds_read_b64_tr_b16 v[168:169], v23 offset:6144
  ds_read_b64_tr_b16 v[170:171], v23 offset:6912
  v_xor_b32 v20, 96, v8
  ds_read_b128 v[188:191], v20
  ds_read_b64_tr_b16 v[176:177], v21 offset:9216
  ds_read_b64_tr_b16 v[178:179], v21 offset:9984
  ds_read_b64_tr_b16 v[180:181], v22 offset:9216
  ds_read_b64_tr_b16 v[182:183], v22 offset:9984
  ds_read_b64_tr_b16 v[184:185], v23 offset:9216
  ds_read_b64_tr_b16 v[186:187], v23 offset:9984
.p2align 6
c_loopa:
  s_waitcnt lgkmcnt(0)
  v_mov_b32 v24, s45
  s_add_u32 s60, s60, 28672
  ds_write_b32 v9, v24 offset:6160
  s_cmp_ge_u32 s60, 155648
  s_cselect_b32 s60, 12288, s60
  v_add_u32 v8, s60, v7
  v_add_u32 v21, s60, v17
  v_mad_u32_u24 v22, v28, s60, v18
  v_add_u32 v23, s60, v19
  ds_read_b32 v15, v10 offset:6144

  v_dot2c_f32_bf16 v33, s61, v128
  v_dot2c_f32_bf16 v29, v140, v140
  v_dot2c_f32_bf16 v34, s61, v129
  v_dot2c_f32_bf16 v30, v141, v141
  v_dot2c_f32_bf16 v33, s61, v130
  v_dot2c_f32_bf16 v31, v142, v142
  v_dot2c_f32_bf16 v34, s61, v131
  v_dot2c_f32_bf16 v32, v143, v143
  v_dot2c_f32_bf16 v33, s61, v144
  v_dot2c_f32_bf16 v29, v156, v156
  v_dot2c_f32_bf16 v34, s61, v145
  v_dot2c_f32_bf16 v30, v157, v157
  v_dot2c_f32_bf16 v33, s61, v146
  v_dot2c_f32_bf16 v31, v158, v158
  v_dot2c_f32_bf16 v34, s61, v147
  v_dot2c_f32_bf16 v32, v159, v159
  v_dot2c_f32_bf16 v33, s61, v160
  v_dot2c_f32_bf16 v29, v172, v172
  v_dot2c_f32_bf16 v34, s61, v161
  v_dot2c_f32_bf16 v30, v173, v173
  v_dot2c_f32_bf16 v33, s61, v162
  v_dot2c_f32_bf16 v31, v174, v174
  v_dot2c_f32_bf16 v34, s61, v163
  v_dot2c_f32_bf16 v32, v175, v175
  v_dot2c_f32_bf16 v33, s61, v176
  v_dot2c_f32_bf16 v29, v188, v188
  v_dot2c_f32_bf16 v34, s61, v177
  v_dot2c_f32_bf16 v30, v189, v189
  v_dot2c_f32_bf16 v33, s61, v178
  v_dot2c_f32_bf16 v31, v190, v190
  v_dot2c_f32_bf16 v34, s61, v179
  v_dot2c_f32_bf16 v32, v191, v191
  v_mfma_f32_32x32x16_bf16 v[80:95], v[128:131], v[140:143], v[80:95]
  s_waitcnt lgkmcnt(0)
  v_cmp_ge_u32 vcc, s45, v15
  s_cbranch_vccnz c_la_slow0

c_la_back0:
  ds_read_b128 v[204:207], v8
  ds_read_b64_tr_b16 v[192:193], v21 offset:0
  v_mfma_f32_32x32x16_bf16 v[96:111], v[132:135], v[140:143], v[96:111]
  ds_read_b64_tr_b16 v[194:195], v21 offset:768
  ds_read_b64_tr_b16 v[196:197], v22 offset:0
  ds_read_b64_tr_b16 v[198:199], v22 offset:768
  v_mfma_f32_32x32x16_bf16 v[112:127], v[136:139], v[140:143], v[112:127]
  ds_read_b64_tr_b16 v[200:201], v23 offset:0
  ds_read_b64_tr_b16 v[202:203], v23 offset:768
  v_xor_b32 v20, 32, v8
  ds_read_b128 v[220:223], v20
  v_mfma_f32_32x32x16_bf16 v[80:95], v[144:147], v[156:159], v[80:95]
  ds_read_b64_tr_b16 v[208:209], v21 offset:3072
  ds_read_b64_tr_b16 v[210:211], v21 offset:3840
  ds_read_b64_tr_b16 v[212:213], v22 offset:3072
  v_mfma_f32_32x32x16_bf16 v[96:111], v[148:151], v[156:159], v[96:111]
  ds_read_b64_tr_b16 v[214:215], v22 offset:3840
  ds_read_b64_tr_b16 v[216:217], v23 offset:3072
  ds_read_b64_tr_b16 v[218:219], v23 offset:3840
  v_mfma_f32_32x32x16_bf16 v[112:127], v[152:155], v[156:159], v[112:127]
  s_waitcnt lgkmcnt(5)
  v_xor_b32 v20, 64, v8
  ds_read_b128 v[236:239], v20
  ds_read_b64_tr_b16 v[224:225], v21 offset:6144
  ds_read_b64_tr_b16 v[226:227], v21 offset:6912
  v_mfma_f32_32x32x16_bf16 v[80:95], v[160:163], v[172:175], v[80:95]
  ds_read_b64_tr_b16 v[228:229], v22 offset:6144
  ds_read_b64_tr_b16 v[230:231], v22 offset:6912
  ds_read_b64_tr_b16 v[232:233], v23 offset:6144
  v_mfma_f32_32x32x16_bf16 v[96:111], v[164:167], v[172:175], v[96:111]
  ds_read_b64_tr_b16 v[234:235], v23 offset:6912
  v_xor_b32 v20, 96, v8
  ds_read_b128 v[252:255], v20
  ds_read_b64_tr_b16 v[240:241], v21 offset:9216
  v_mfma_f32_32x32x16_bf16 v[112:127], v[168:171], v[172:175], v[112:127]
  s_waitcnt lgkmcnt(5)
  ds_read_b64_tr_b16 v[242:243], v21 offset:9984
  ds_read_b64_tr_b16 v[244:245], v22 offset:9216
  ds_read_b64_tr_b16 v[246:247], v22 offset:9984
  v_mfma_f32_32x32x16_bf16 v[80:95], v[176:179], v[188:191], v[80:95]
  ds_read_b64_tr_b16 v[248:249], v23 offset:9216
  ds_read_b64_tr_b16 v[250:251], v23 offset:9984
  v_mfma_f32_32x32x16_bf16 v[96:111], v[180:183], v[188:191], v[96:111]
  v_mfma_f32_32x32x16_bf16 v[112:127], v[184:187], v[188:191], v[112:127]
  s_add_u32 s45, s45, 1
  s_cmp_eq_u32 s45, 8
  s_cbranch_scc1 c_posta

c_loopa2:
  s_waitcnt lgkmcnt(0)
  v_mov_b32 v24, s45
  s_add_u32 s60, s60, 28672
  ds_write_b32 v9, v24 offset:6160
  s_cmp_ge_u32 s60, 155648
  s_cselect_b32 s60, 12288, s60
  v_add_u32 v8, s60, v7
  v_add_u32 v21, s60, v17
  v_mad_u32_u24 v22, v28, s60, v18
  v_add_u32 v23, s60, v19
  ds_read_b32 v15, v10 offset:6144

  v_dot2c_f32_bf16 v33, s61, v192
  v_dot2c_f32_bf16 v29, v204, v204
  v_dot2c_f32_bf16 v34, s61, v193
  v_dot2c_f32_bf16 v30, v205, v205
  v_dot2c_f32_bf16 v33, s61, v194
  v_dot2c_f32_bf16 v31, v206, v206
  v_dot2c_f32_bf16 v34, s61, v195
  v_dot2c_f32_bf16 v32, v207, v207
  v_dot2c_f32_bf16 v33, s61, v208
  v_dot2c_f32_bf16 v29, v220, v220
  v_dot2c_f32_bf16 v34, s61, v209
  v_dot2c_f32_bf16 v30, v221, v221
  v_dot2c_f32_bf16 v33, s61, v210
  v_dot2c_f32_bf16 v31, v222, v222
  v_dot2c_f32_bf16 v34, s61, v211
  v_dot2c_f32_bf16 v32, v223, v223
  v_dot2c_f32_bf16 v33, s61, v224
  v_dot2c_f32_bf16 v29, v236, v236
  v_dot2c_f32_bf16 v34, s61, v225
  v_dot2c_f32_bf16 v30, v237, v237
  v_dot2c_f32_bf16 v33, s61, v226
  v_dot2c_f32_bf16 v31, v238, v238
  v_dot2c_f32_bf16 v34, s61, v227
  v_dot2c_f32_bf16 v32, v239, v239
  v_dot2c_f32_bf16 v33, s61, v240
  v_dot2c_f32_bf16 v29, v252, v252
  v_dot2c_f32_bf16 v34, s61, v241
  v_dot2c_f32_bf16 v30, v253, v253
  v_dot2c_f32_bf16 v33, s61, v242
  v_dot2c_f32_bf16 v31, v254, v254
  v_dot2c_f32_bf16 v34, s61, v243
  v_dot2c_f32_bf16 v32, v255, v255
  v_mfma_f32_32x32x16_bf16 v[80:95], v[192:195], v[204:207], v[80:95]
  s_waitcnt lgkmcnt(0)
  v_cmp_ge_u32 vcc, s45, v15
  s_cbranch_vccnz c_la_slow1

c_la_back1:
  ds_read_b128 v[140:143], v8
  ds_read_b64_tr_b16 v[128:129], v21 offset:0
  v_mfma_f32_32x32x16_bf16 v[96:111], v[196:199], v[204:207], v[96:111]
  ds_read_b64_tr_b16 v[130:131], v21 offset:768
  ds_read_b64_tr_b16 v[132:133], v22 offset:0
  ds_read_b64_tr_b16 v[134:135], v22 offset:768
  v_mfma_f32_32x32x16_bf16 v[112:127], v[200:203], v[204:207], v[112:127]
  ds_read_b64_tr_b16 v[136:137], v23 offset:0
  ds_read_b64_tr_b16 v[138:139], v23 offset:768
  v_xor_b32 v20, 32, v8
  ds_read_b128 v[156:159], v20
  v_mfma_f32_32x32x16_bf16 v[80:95], v[208:211], v[220:223], v[80:95]
  ds_read_b64_tr_b16 v[144:145], v21 offset:3072
  ds_read_b64_tr_b16 v[146:147], v21 offset:3840
  ds_read_b64_tr_b16 v[148:149], v22 offset:3072
  v_mfma_f32_32x32x16_bf16 v[96:111], v[212:215], v[220:223], v[96:111]
  ds_read_b64_tr_b16 v[150:151], v22 offset:3840
  ds_read_b64_tr_b16 v[152:153], v23 offset:3072
  ds_read_b64_tr_b16 v[154:155], v23 offset:3840
  v_mfma_f32_32x32x16_bf16 v[112:127], v[216:219], v[220:223], v[112:127]
  s_waitcnt lgkmcnt(5)
  v_xor_b32 v20, 64, v8
  ds_read_b128 v[172:175], v20
  ds_read_b64_tr_b16 v[160:161], v21 offset:6144
  ds_read_b64_tr_b16 v[162:163], v21 offset:6912
  v_mfma_f32_32x32x16_bf16 v[80:95], v[224:227], v[236:239], v[80:95]
  ds_read_b64_tr_b16 v[164:165], v22 offset:6144
  ds_read_b64_tr_b16 v[166:167], v22 offset:6912
  ds_read_b64_tr_b16 v[168:169], v23 offset:6144
  v_mfma_f32_32x32x16_bf16 v[96:111], v[228:231], v[236:239], v[96:111]
  ds_read_b64_tr_b16 v[170:171], v23 offset:6912
  v_xor_b32 v20, 96, v8
  ds_read_b128 v[188:191], v20
  ds_read_b64_tr_b16 v[176:177], v21 offset:9216
  v_mfma_f32_32x32x16_bf16 v[112:127], v[232:235], v[236:239], v[112:127]
  s_waitcnt lgkmcnt(5)
  ds_read_b64_tr_b16 v[178:179], v21 offset:9984
  ds_read_b64_tr_b16 v[180:181], v22 offset:9216
  ds_read_b64_tr_b16 v[182:183], v22 offset:9984
  v_mfma_f32_32x32x16_bf16 v[80:95], v[240:243], v[252:255], v[80:95]
  ds_read_b64_tr_b16 v[184:185], v23 offset:9216
  ds_read_b64_tr_b16 v[186:187], v23 offset:9984
  v_mfma_f32_32x32x16_bf16 v[96:111], v[244:247], v[252:255], v[96:111]
  v_mfma_f32_32x32x16_bf16 v[112:127], v[248:251], v[252:255], v[112:127]
  s_add_u32 s45, s45, 1
  s_branch c_loopa
c_posta:
  buffer_load_dwordx2 v[18:19], v0, s[32:35], 0 offen sc1
  v_add_f32 v33, v33, v34
  v_add_f32 v29, v29, v30
  v_add_f32 v31, v31, v32
  v_mov_b32 v34, v33
  v_and_b32 v27, 31, v1
  v_lshlrev_b32 v27, 2, v27
  v_permlane32_swap_b32 v33, v34
  v_add_f32 v29, v29, v31
  v_add_u32 v27, s54, v27
  v_add_f32 v33, v33, v34
  v_add_u32 v27, 159744, v27
  v_mov_b32 v30, v29
  ds_write_b32 v27, v33
  v_mov_b32 v31, 8
  ds_write_b32 v9, v31 offset:6160
  v_mov_b32 v25, v108
  v_mov_b32 v26, v108
  v_permlane32_swap_b32 v29, v30
  s_nop 0
  v_permlane32_swap_b32 v25, v26
  v_add_f32 v29, v29, v30
  v_mul_f32 v29, 0x3b124925, v29
  v_mul_f32 v12, 0xbb124925, v26
  v_fma_f32 v29, -v12, v12, v29
  v_max_f32 v29, 0, v29
  v_add_f32 v29, 0x3727c5ac, v29
  v_rsq_f32 v13, v29
  s_lshl_b32 s42, s39, 8
  s_add_u32 s42, s42, 160768
  v_and_b32 v27, 31, v1
  v_lshlrev_b32 v27, 3, v27
  v_add_u32 v27, s42, v27
  ds_write_b64 v27, v[12:13]

  s_mov_b32 s78, 4194304
lw_5:
  ds_read_b32 v15, v10 offset:6160
  s_waitcnt lgkmcnt(0)
  v_cmp_gt_u32 vcc, 8, v15
  s_cbranch_vccz lwd_6
  s_sleep 0
  s_sub_u32 s78, s78, 1
  s_cbranch_scc0 lw_5

lwd_6:
c_epi:
  v_add_u32 v8, s54, v35
  ds_read_b128 v[40:43], v8 offset:0
  ds_read_b128 v[44:47], v8 offset:32
  ds_read_b128 v[48:51], v8 offset:64
  ds_read_b128 v[52:55], v8 offset:96
  v_add_u32 v8, s55, v35
  ds_read_b128 v[56:59], v8 offset:0
  ds_read_b128 v[60:63], v8 offset:32
  ds_read_b128 v[64:67], v8 offset:64
  ds_read_b128 v[68:71], v8 offset:96
  s_waitcnt lgkmcnt(4)
  v_mul_f32 v14, s50, v13
  v_fmac_f32 v80, v40, v12
  v_fmac_f32 v81, v41, v12
  v_fmac_f32 v82, v42, v12
  v_fmac_f32 v83, v43, v12
  v_fmac_f32 v84, v44, v12
  v_fmac_f32 v85, v45, v12
  v_fmac_f32 v86, v46, v12
  v_fmac_f32 v87, v47, v12
  v_fmac_f32 v88, v48, v12
  v_fmac_f32 v89, v49, v12
  v_fmac_f32 v90, v50, v12
  v_fmac_f32 v91, v51, v12
  v_fmac_f32 v92, v52, v12
  v_fmac_f32 v93, v53, v12
  v_fmac_f32 v94, v54, v12
  v_fmac_f32 v95, v55, v12
  v_mul_f32 v80, v14, v80
  v_mul_f32 v81, v14, v81
  v_mul_f32 v82, v14, v82
  v_mul_f32 v83, v14, v83
  v_mul_f32 v84, v14, v84
  v_mul_f32 v85, v14, v85
  v_mul_f32 v86, v14, v86
  v_mul_f32 v87, v14, v87
  v_mul_f32 v88, v14, v88
  v_mul_f32 v89, v14, v89
  v_mul_f32 v90, v14, v90
  v_mul_f32 v91, v14, v91
  v_mul_f32 v92, v14, v92
  v_mul_f32 v93, v14, v93
  v_mul_f32 v94, v14, v94
  v_mul_f32 v95, v14, v95
  v_cvt_pk_bf16_f32 v80, v80, v81
  v_cvt_pk_bf16_f32 v81, v82, v83
  v_cvt_pk_bf16_f32 v82, v84, v85
  v_cvt_pk_bf16_f32 v83, v86, v87
  v_cvt_pk_bf16_f32 v84, v88, v89
  v_cvt_pk_bf16_f32 v85, v90, v91
  v_cvt_pk_bf16_f32 v86, v92, v93
  v_cvt_pk_bf16_f32 v87, v94, v95
  v_pk_max_i16 v80, v80, s58
  v_pk_max_i16 v81, v81, s58
  v_pk_max_i16 v82, v82, s58
  v_pk_max_i16 v83, v83, s58
  v_pk_max_i16 v84, v84, s58
  v_pk_max_i16 v85, v85, s58
  buffer_store_dwordx4 v[80:83], v2, s[20:23], s46 offen sc1
  v_pk_max_i16 v86, v86, s58
  v_pk_max_i16 v87, v87, s58
  v_and_or_b32 v86, v86, v5, v6
  v_and_b32 v87, v87, v5
  buffer_store_dwordx4 v[84:87], v2, s[20:23], s46 offen offset:1024 sc1
  v_add_u32 v8, s56, v35
  ds_read_b128 v[40:43], v8 offset:0
  ds_read_b128 v[44:47], v8 offset:32
  ds_read_b128 v[48:51], v8 offset:64
  ds_read_b128 v[52:55], v8 offset:96
  s_waitcnt lgkmcnt(4)
  v_mul_f32 v14, s51, v13
  v_fmac_f32 v96, v56, v12
  v_fmac_f32 v97, v57, v12
  v_fmac_f32 v98, v58, v12
  v_fmac_f32 v99, v59, v12
  v_fmac_f32 v100, v60, v12
  v_fmac_f32 v101, v61, v12
  v_fmac_f32 v102, v62, v12
  v_fmac_f32 v103, v63, v12
  v_fmac_f32 v104, v64, v12
  v_fmac_f32 v105, v65, v12
  v_fmac_f32 v106, v66, v12
  v_fmac_f32 v107, v67, v12
  v_fmac_f32 v108, v68, v12
  v_fmac_f32 v109, v69, v12
  v_fmac_f32 v110, v70, v12
  v_fmac_f32 v111, v71, v12
  v_mul_f32 v96, v14, v96
  v_mul_f32 v97, v14, v97
  v_mul_f32 v98, v14, v98
  v_mul_f32 v99, v14, v99
  v_mul_f32 v100, v14, v100
  v_mul_f32 v101, v14, v101
  v_mul_f32 v102, v14, v102
  v_mul_f32 v103, v14, v103
  v_mul_f32 v104, v14, v104
  v_mul_f32 v105, v14, v105
  v_mul_f32 v106, v14, v106
  v_mul_f32 v107, v14, v107
  v_mul_f32 v108, v14, v108
  v_mul_f32 v109, v14, v109
  v_mul_f32 v110, v14, v110
  v_mul_f32 v111, v14, v111
  v_cvt_pk_bf16_f32 v96, v96, v97
  v_cvt_pk_bf16_f32 v97, v98, v99
  v_cvt_pk_bf16_f32 v98, v100, v101
  v_cvt_pk_bf16_f32 v99, v102, v103
  v_cvt_pk_bf16_f32 v100, v104, v105
  v_cvt_pk_bf16_f32 v101, v106, v107
  v_cvt_pk_bf16_f32 v102, v108, v109
  v_cvt_pk_bf16_f32 v103, v110, v111
  v_pk_max_i16 v96, v96, s58
  v_pk_max_i16 v97, v97, s58
  v_pk_max_i16 v98, v98, s58
  v_pk_max_i16 v99, v99, s58
  v_pk_max_i16 v100, v100, s58
  v_pk_max_i16 v101, v101, s58
  buffer_store_dwordx4 v[96:99], v2, s[20:23], s47 offen sc1
  v_pk_max_i16 v102, v102, s58
  v_pk_max_i16 v103, v103, s58
  v_and_or_b32 v102, v102, v5, v6
  v_and_b32 v103, v103, v5
  buffer_store_dwordx4 v[100:103], v2, s[20:23], s47 offen offset:1024 sc1
c_epi2:
  v_add_u32 v8, s57, v35
  ds_read_b128 v[56:59], v8 offset:0
  ds_read_b128 v[60:63], v8 offset:32
  ds_read_b128 v[64:67], v8 offset:64
  ds_read_b128 v[68:71], v8 offset:96
  s_waitcnt lgkmcnt(4)
  v_mul_f32 v14, s52, v13
  v_fmac_f32 v112, v40, v12
  v_fmac_f32 v113, v41, v12
  v_fmac_f32 v114, v42, v12
  v_fmac_f32 v115, v43, v12
  v_fmac_f32 v116, v44, v12
  v_fmac_f32 v117, v45, v12
  v_fmac_f32 v118, v46, v12
  v_fmac_f32 v119, v47, v12
  v_fmac_f32 v120, v48, v12
  v_fmac_f32 v121, v49, v12
  v_fmac_f32 v122, v50, v12
  v_fmac_f32 v123, v51, v12
  v_fmac_f32 v124, v52, v12
  v_fmac_f32 v125, v53, v12
  v_fmac_f32 v126, v54, v12
  v_fmac_f32 v127, v55, v12
  v_mul_f32 v112, v14, v112
  v_mul_f32 v113, v14, v113
  v_mul_f32 v114, v14, v114
  v_mul_f32 v115, v14, v115
  v_mul_f32 v116, v14, v116
  v_mul_f32 v117, v14, v117
  v_mul_f32 v118, v14, v118
  v_mul_f32 v119, v14, v119
  v_mul_f32 v120, v14, v120
  v_mul_f32 v121, v14, v121
  v_mul_f32 v122, v14, v122
  v_mul_f32 v123, v14, v123
  v_mul_f32 v124, v14, v124
  v_mul_f32 v125, v14, v125
  v_mul_f32 v126, v14, v126
  v_mul_f32 v127, v14, v127
  v_cvt_pk_bf16_f32 v112, v112, v113
  v_cvt_pk_bf16_f32 v113, v114, v115
  v_cvt_pk_bf16_f32 v114, v116, v117
  v_cvt_pk_bf16_f32 v115, v118, v119
  v_cvt_pk_bf16_f32 v116, v120, v121
  v_cvt_pk_bf16_f32 v117, v122, v123
  v_cvt_pk_bf16_f32 v118, v124, v125
  v_cvt_pk_bf16_f32 v119, v126, v127
  v_pk_max_i16 v112, v112, s58
  v_pk_max_i16 v113, v113, s58
  v_pk_max_i16 v114, v114, s58
  v_pk_max_i16 v115, v115, s58
  v_pk_max_i16 v116, v116, s58
  v_pk_max_i16 v117, v117, s58
  buffer_store_dwordx4 v[112:115], v2, s[20:23], s48 offen sc1
  v_pk_max_i16 v118, v118, s58
  v_pk_max_i16 v119, v119, s58
  v_and_or_b32 v118, v118, v5, v6
  v_and_b32 v119, v119, v5
  buffer_store_dwordx4 v[116:119], v2, s[20:23], s48 offen offset:1024 sc1
  s_cmp_eq_u32 s59, 1
  s_cbranch_scc1 c_epi_end
c_epi3:
  s_waitcnt lgkmcnt(0)
  v_mul_f32 v14, s53, v13
  v_fmac_f32 v128, v56, v12
  v_fmac_f32 v129, v57, v12
  v_fmac_f32 v130, v58, v12
  v_fmac_f32 v131, v59, v12
  v_fmac_f32 v132, v60, v12
  v_fmac_f32 v133, v61, v12
  v_fmac_f32 v134, v62, v12
  v_fmac_f32 v135, v63, v12
  v_fmac_f32 v136, v64, v12
  v_fmac_f32 v137, v65, v12
  v_fmac_f32 v138, v66, v12
  v_fmac_f32 v139, v67, v12
  v_fmac_f32 v140, v68, v12
  v_fmac_f32 v141, v69, v12
  v_fmac_f32 v142, v70, v12
  v_fmac_f32 v143, v71, v12
  v_mul_f32 v128, v14, v128
  v_mul_f32 v129, v14, v129
  v_mul_f32 v130, v14, v130
  v_mul_f32 v131, v14, v131
  v_mul_f32 v132, v14, v132
  v_mul_f32 v133, v14, v133
  v_mul_f32 v134, v14, v134
  v_mul_f32 v135, v14, v135
  v_mul_f32 v136, v14, v136
  v_mul_f32 v137, v14, v137
  v_mul_f32 v138, v14, v138
  v_mul_f32 v139, v14, v139
  v_mul_f32 v140, v14, v140
  v_mul_f32 v141, v14, v141
  v_mul_f32 v142, v14, v142
  v_mul_f32 v143, v14, v143
  v_cvt_pk_bf16_f32 v128, v128, v129
  v_cvt_pk_bf16_f32 v129, v130, v131
  v_cvt_pk_bf16_f32 v130, v132, v133
  v_cvt_pk_bf16_f32 v131, v134, v135
  v_cvt_pk_bf16_f32 v132, v136, v137
  v_cvt_pk_bf16_f32 v133, v138, v139
  v_cvt_pk_bf16_f32 v134, v140, v141
  v_cvt_pk_bf16_f32 v135, v142, v143
  v_pk_max_i16 v128, v128, s58
  v_pk_max_i16 v129, v129, s58
  v_pk_max_i16 v130, v130, s58
  v_pk_max_i16 v131, v131, s58
  v_pk_max_i16 v132, v132, s58
  v_pk_max_i16 v133, v133, s58
  buffer_store_dwordx4 v[128:131], v2, s[20:23], s49 offen sc1
  v_pk_max_i16 v134, v134, s58
  v_pk_max_i16 v135, v135, s58
  v_and_or_b32 v134, v134, v5, v6
  v_and_b32 v135, v135, v5
  buffer_store_dwordx4 v[132:135], v2, s[20:23], s49 offen offset:1024 sc1
  s_nop 1
  v_mfma_f32_32x32x16_bf16 v[80:95], v[36:39], v[36:39], 0
  v_mfma_f32_32x32x16_bf16 v[96:111], v[36:39], v[36:39], 0
  v_mfma_f32_32x32x16_bf16 v[112:127], v[36:39], v[36:39], 0
  v_mfma_f32_32x32x16_bf16 v[128:143], v[36:39], v[36:39], 0
  s_branch c_done
c_epi_end:
  v_mov_b32 v25, 9
  ds_write_b32 v9, v25 offset:6160
  s_mul_i32 s42, s41, 3
  s_lshr_b32 s43, s40, 2
  v_lshrrev_b32 v26, 4, v1
  v_add_u32 v26, s42, v26
  v_and_b32 v27, 15, v26
  v_lshrrev_b32 v26, 4, v26
  v_and_b32 v28, 15, v1
  v_lshl_add_u32 v27, v27, 4, v28
  v_lshlrev_b32 v27, 9, v27
  v_lshlrev_b32 v17, 4, v26
  v_add_u32 v17, s43, v17
  v_lshl_add_u32 v17, v17, 3, v27
  v_add_u32 v17, 17825792, v17
  v_cmp_eq_u32 vcc, 0, v26
  v_cmp_ne_u32 s[72:73], s43, v28
  s_and_b64 vcc, vcc, s[72:73]
  v_cmp_lt_u32 s[72:73], 47, v1
  s_or_b64 vcc, vcc, s[72:73]
  v_mov_b32 v26, 0x40000000
  s_nop 0
  v_cndmask_b32 v17, v17, v26, vcc

  s_branch x_attn
c_passb:
  s_setprio 2
  s_mov_b32 s32, s18
  s_mov_b32 s33, s19
  s_mov_b32 s34, 256

  s_waitcnt lgkmcnt(0)
  buffer_load_dwordx2 v[18:19], v0, s[32:35], 0 offen sc1
  v_lshrrev_b32 v3, 5, v1
  v_bfe_u32 v26, v1, 2, 2
  v_bfe_u32 v27, v1, 4, 1
  v_and_b32 v28, 3, v1
  v_lshlrev_b32 v27, 5, v27
  v_lshl_add_u32 v27, v28, 3, v27
  v_lshl_add_u32 v29, v3, 3, v26
  v_mov_b32 v36, 0
  v_mov_b32 v37, 0
  v_mov_b32 v38, 0
  v_mov_b32 v39, 0
  v_lshlrev_b32 v35, 4, v3
  v_add_u32 v35, 159744, v35
  v_lshlrev_b32 v16, 8, v29
  v_add_u32 v16, v16, v27
  v_lshlrev_b32 v32, 6, v26
  v_or_b32 v16, v16, v32
  s_lshl_b32 s42, s39, 6
  v_xor_b32 v16, s42, v16
  s_mov_b32 s61, 0x3f803f80

  v_mfma_f32_32x32x16_bf16 v[80:95], v[36:39], v[36:39], 0
  v_mov_b32 v29, 0
  v_xor_b32 v21, 0, v16
  v_add_u32 v21, 40960, v21
  v_mfma_f32_32x32x16_bf16 v[96:111], v[36:39], v[36:39], 0
  v_mov_b32 v30, 0
  v_xor_b32 v22, 64, v16
  v_add_u32 v22, 40960, v22
  v_mfma_f32_32x32x16_bf16 v[112:127], v[36:39], v[36:39], 0
  v_mov_b32 v31, 0
  v_xor_b32 v23, 128, v16
  v_add_u32 v23, 40960, v23
  v_mfma_f32_32x32x16_bf16 v[128:143], v[36:39], v[36:39], 0
  v_mov_b32 v32, 0
  v_xor_b32 v24, 192, v16
  v_add_u32 v24, 40960, v24
  s_mov_b32 s78, 4194304
lw_7:
  ds_read_b32 v15, v10 offset:6144
  s_waitcnt lgkmcnt(0)
  v_cmp_gt_u32 vcc, 10, v15
  s_cbranch_vccz lwd_8
  s_sleep 1
  s_sub_u32 s78, s78, 1
  s_cbranch_scc0 lw_7

lwd_8:
  s_mov_b32 s45, 0
  s_mov_b32 s62, 0

  ds_read_b64_tr_b16 v[40:41], v21 offset:0
  ds_read_b64_tr_b16 v[42:43], v21 offset:1024
  ds_read_b64_tr_b16 v[44:45], v22 offset:0
  ds_read_b64_tr_b16 v[46:47], v22 offset:1024
  ds_read_b64_tr_b16 v[48:49], v23 offset:0
  ds_read_b64_tr_b16 v[50:51], v23 offset:1024
  ds_read_b64_tr_b16 v[52:53], v24 offset:0
  ds_read_b64_tr_b16 v[54:55], v24 offset:1024
  s_waitcnt lgkmcnt(4)
  ds_read_b64_tr_b16 v[60:61], v21 offset:4096
  ds_read_b64_tr_b16 v[62:63], v21 offset:5120
  ds_read_b64_tr_b16 v[64:65], v22 offset:4096
  ds_read_b64_tr_b16 v[66:67], v22 offset:5120
  ds_read_b64_tr_b16 v[68:69], v23 offset:4096
  ds_read_b64_tr_b16 v[70:71], v23 offset:5120
  ds_read_b64_tr_b16 v[72:73], v24 offset:4096
  ds_read_b64_tr_b16 v[74:75], v24 offset:5120
  s_set_gpr_idx_on s62, gpr_idx(SRC0)
  v_mov_b32 v56, v144
  v_mov_b32 v57, v145
  s_set_gpr_idx_off
  s_set_gpr_idx_on s62, gpr_idx(SRC0)
  v_mov_b32 v58, v146
  v_mov_b32 v59, v147
  s_set_gpr_idx_off
.p2align 6
c_loopb:
  s_bitcmp1_b32 0x14, s45
  s_cbranch_scc1 c_lb_rare

c_lb_go:
  s_waitcnt lgkmcnt(11)
  v_dot2c_f32_bf16 v29, s61, v40
  v_dot2c_f32_bf16 v30, s61, v41
  v_dot2c_f32_bf16 v31, s61, v42
  v_dot2c_f32_bf16 v32, s61, v43
  v_mfma_f32_32x32x16_bf16 v[80:95], v[40:43], v[56:59], v[80:95]
  ds_read_b64_tr_b16 v[40:41], v21 offset:8192
  ds_read_b64_tr_b16 v[42:43], v21 offset:9216
  s_set_gpr_idx_on s62, gpr_idx(SRC0)
  v_mov_b32 v76, v148
  v_mov_b32 v77, v149
  s_set_gpr_idx_off
  v_mfma_f32_32x32x16_bf16 v[96:111], v[44:47], v[56:59], v[96:111]
  ds_read_b64_tr_b16 v[44:45], v22 offset:8192
  ds_read_b64_tr_b16 v[46:47], v22 offset:9216
  s_waitcnt lgkmcnt(11)
  v_mfma_f32_32x32x16_bf16 v[112:127], v[48:51], v[56:59], v[112:127]
  ds_read_b64_tr_b16 v[48:49], v23 offset:8192
  ds_read_b64_tr_b16 v[50:51], v23 offset:9216
  s_set_gpr_idx_on s62, gpr_idx(SRC0)
  v_mov_b32 v78, v150
  v_mov_b32 v79, v151
  s_set_gpr_idx_off
  v_mfma_f32_32x32x16_bf16 v[128:143], v[52:55], v[56:59], v[128:143]
  ds_read_b64_tr_b16 v[52:53], v24 offset:8192
  ds_read_b64_tr_b16 v[54:55], v24 offset:9216
  s_waitcnt lgkmcnt(11)
  v_dot2c_f32_bf16 v29, s61, v60
  v_dot2c_f32_bf16 v30, s61, v61
  v_dot2c_f32_bf16 v31, s61, v62
  v_dot2c_f32_bf16 v32, s61, v63
  v_mfma_f32_32x32x16_bf16 v[80:95], v[60:63], v[76:79], v[80:95]
  ds_read_b64_tr_b16 v[60:61], v21 offset:12288
  ds_read_b64_tr_b16 v[62:63], v21 offset:13312
  s_set_gpr_idx_on s62, gpr_idx(SRC0)
  v_mov_b32 v56, v152
  v_mov_b32 v57, v153
  s_set_gpr_idx_off
  v_mfma_f32_32x32x16_bf16 v[96:111], v[64:67], v[76:79], v[96:111]
  ds_read_b64_tr_b16 v[64:65], v22 offset:12288
  ds_read_b64_tr_b16 v[66:67], v22 offset:13312
  s_waitcnt lgkmcnt(11)
  v_mfma_f32_32x32x16_bf16 v[112:127], v[68:71], v[76:79], v[112:127]
  ds_read_b64_tr_b16 v[68:69], v23 offset:12288
  ds_read_b64_tr_b16 v[70:71], v23 offset:13312
  s_set_gpr_idx_on s62, gpr_idx(SRC0)
  v_mov_b32 v58, v154
  v_mov_b32 v59, v155
  s_set_gpr_idx_off
  v_mfma_f32_32x32x16_bf16 v[128:143], v[72:75], v[76:79], v[128:143]
  ds_read_b64_tr_b16 v[72:73], v24 offset:12288
  ds_read_b64_tr_b16 v[74:75], v24 offset:13312
  s_waitcnt lgkmcnt(11)
  v_dot2c_f32_bf16 v29, s61, v40
  v_dot2c_f32_bf16 v30, s61, v41
  v_dot2c_f32_bf16 v31, s61, v42
  v_dot2c_f32_bf16 v32, s61, v43
  v_mfma_f32_32x32x16_bf16 v[80:95], v[40:43], v[56:59], v[80:95]
  ds_read_b64_tr_b16 v[40:41], v21 offset:16384
  ds_read_b64_tr_b16 v[42:43], v21 offset:17408
  s_set_gpr_idx_on s62, gpr_idx(SRC0)
  v_mov_b32 v76, v156
  v_mov_b32 v77, v157
  s_set_gpr_idx_off
  v_mfma_f32_32x32x16_bf16 v[96:111], v[44:47], v[56:59], v[96:111]
  ds_read_b64_tr_b16 v[44:45], v22 offset:16384
  ds_read_b64_tr_b16 v[46:47], v22 offset:17408
  s_waitcnt lgkmcnt(11)
  v_mfma_f32_32x32x16_bf16 v[112:127], v[48:51], v[56:59], v[112:127]
  ds_read_b64_tr_b16 v[48:49], v23 offset:16384
  ds_read_b64_tr_b16 v[50:51], v23 offset:17408
  s_set_gpr_idx_on s62, gpr_idx(SRC0)
  v_mov_b32 v78, v158
  v_mov_b32 v79, v159
  s_set_gpr_idx_off
  v_mfma_f32_32x32x16_bf16 v[128:143], v[52:55], v[56:59], v[128:143]
  ds_read_b64_tr_b16 v[52:53], v24 offset:16384
  ds_read_b64_tr_b16 v[54:55], v24 offset:17408
  s_add_u32 s62, s62, 16
  s_min_u32 s62, s62, 96
  s_waitcnt lgkmcnt(11)
  v_dot2c_f32_bf16 v29, s61, v60
  v_dot2c_f32_bf16 v30, s61, v61
  v_dot2c_f32_bf16 v31, s61, v62
  v_dot2c_f32_bf16 v32, s61, v63
  v_mfma_f32_32x32x16_bf16 v[80:95], v[60:63], v[76:79], v[80:95]
  ds_read_b64_tr_b16 v[60:61], v21 offset:20480
  ds_read_b64_tr_b16 v[62:63], v21 offset:21504
  s_set_gpr_idx_on s62, gpr_idx(SRC0)
  v_mov_b32 v56, v144
  v_mov_b32 v57, v145
  s_set_gpr_idx_off
  v_add_u32 v21, 16384, v21
  v_mfma_f32_32x32x16_bf16 v[96:111], v[64:67], v[76:79], v[96:111]
  ds_read_b64_tr_b16 v[64:65], v22 offset:20480
  ds_read_b64_tr_b16 v[66:67], v22 offset:21504
  v_add_u32 v22, 16384, v22
  s_waitcnt lgkmcnt(11)
  v_mfma_f32_32x32x16_bf16 v[112:127], v[68:71], v[76:79], v[112:127]
  ds_read_b64_tr_b16 v[68:69], v23 offset:20480
  ds_read_b64_tr_b16 v[70:71], v23 offset:21504
  s_set_gpr_idx_on s62, gpr_idx(SRC0)
  v_mov_b32 v58, v146
  v_mov_b32 v59, v147
  s_set_gpr_idx_off
  v_add_u32 v23, 16384, v23
  v_mfma_f32_32x32x16_bf16 v[128:143], v[72:75], v[76:79], v[128:143]
  ds_read_b64_tr_b16 v[72:73], v24 offset:20480
  ds_read_b64_tr_b16 v[74:75], v24 offset:21504
  v_add_u32 v24, 16384, v24
  s_add_u32 s45, s45, 1
  s_cmp_lt_u32 s45, 7
  s_cbranch_scc1 c_loopb
  s_waitcnt lgkmcnt(0)

  v_add_f32 v29, v29, v30
  v_add_f32 v31, v31, v32
  v_and_b32 v27, 31, v1
  v_add_f32 v29, v29, v31
  v_lshlrev_b32 v27, 2, v27
  v_mov_b32 v30, v29
  s_lshl_b32 s42, s39, 7
  s_add_u32 s42, s42, 160256
  v_permlane32_swap_b32 v29, v30
  v_add_u32 v27, s42, v27
  s_nop 0
  v_add_f32 v29, v29, v30
  ds_write_b32 v27, v29

  v_mov_b32 v25, 2
  ds_write_b32 v9, v25 offset:6192
  s_lshr_b32 s42, s41, 1
  s_mul_i32 s42, s42, 7
  s_and_b32 s43, s41, 1
  s_mul_i32 s43, s43, 3
  s_add_u32 s42, s42, s43
  s_mul_i32 s43, s40, 72
  s_add_u32 s42, s42, s43
  s_lshl_b32 s42, s42, 11
  s_add_u32 s42, s42, 7340032
  s_and_b32 s62, s41, 1
  s_sub_u32 s62, s62, 1
  s_mov_b32 s58, 0
  v_mov_b32 v5, -1
  v_mov_b32 v6, 0
  s_mov_b32 s59, 2

  s_mov_b32 s50, 1.0
  s_xor_b32 s43, s39, 0
  s_lshl_b32 s44, s43, 7
  s_add_u32 s54, s44, 512
  s_lshl_b32 s43, s43, 11
  s_add_u32 s46, s42, s43
  s_cmp_eq_u32 s43, s62
  s_cselect_b32 s46, 0x40000000, s46

  s_mov_b32 s51, 1.0
  s_xor_b32 s43, s39, 1
  s_lshl_b32 s44, s43, 7
  s_add_u32 s55, s44, 512
  s_lshl_b32 s43, s43, 11
  s_add_u32 s47, s42, s43
  s_cmp_eq_u32 s43, s62
  s_cselect_b32 s47, 0x40000000, s47

  s_mov_b32 s52, 1.0
  s_xor_b32 s43, s39, 2
  s_lshl_b32 s44, s43, 7
  s_add_u32 s56, s44, 512
  s_lshl_b32 s43, s43, 11
  s_add_u32 s48, s42, s43
  s_cmp_eq_u32 s43, s62
  s_cselect_b32 s48, 0x40000000, s48

  s_mov_b32 s53, 1.0
  s_xor_b32 s43, s39, 3
  s_lshl_b32 s44, s43, 7
  s_add_u32 s57, s44, 512
  s_lshl_b32 s43, s43, 11
  s_add_u32 s49, s42, s43
  s_cmp_eq_u32 s43, s62
  s_cselect_b32 s49, 0x40000000, s49

  v_readfirstlane_b32 s76, v18
  v_readfirstlane_b32 s77, v19
  s_min_u32 s42, s76, s77
  s_cmp_lg_u32 s42, 0
  s_cbranch_scc1 c_lb_tag2

  s_mov_b32 s78, 524288
tg_9:
  buffer_load_dwordx2 v[26:27], v0, s[32:35], 0 offen sc1
  s_waitcnt vmcnt(0)
  v_readfirstlane_b32 s76, v26
  v_readfirstlane_b32 s77, v27
  s_cbranch_execz tgd_10
  s_min_u32 s42, s76, s77
  s_cmp_lg_u32 s42, 0
  s_cbranch_scc1 tgd_10
  s_sub_u32 s78, s78, 1
  s_cbranch_scc0 tg_9

tgd_10:
c_lb_tag2:
  s_mov_b32 s78, 4194304
lw_11:
  ds_read_b32 v15, v10 offset:6160
  s_waitcnt lgkmcnt(0)
  v_cmp_gt_u32 vcc, 9, v15
  s_cbranch_vccz lwd_12
  s_sleep 1
  s_sub_u32 s78, s78, 1
  s_cbranch_scc0 lw_11

lwd_12:
  s_lshl_b32 s42, s39, 8
  s_add_u32 s42, s42, 160768
  v_and_b32 v27, 31, v1
  v_lshlrev_b32 v27, 3, v27
  v_add_u32 v27, s42, v27
  ds_read_b64 v[12:13], v27

  s_mov_b32 s78, 4194304
lw_13:
  ds_read_b32 v15, v10 offset:6192
  s_waitcnt lgkmcnt(0)
  v_cmp_gt_u32 vcc, 2, v15
  s_cbranch_vccz lwd_14
  s_sleep 0
  s_sub_u32 s78, s78, 1
  s_cbranch_scc0 lw_13

lwd_14:
  s_branch c_epi
c_la_slow0:
  s_cmp_eq_u32 s45, 7
  s_cbranch_scc1 c_la_back0
  s_add_u32 s44, s45, 1

  s_mov_b32 s78, 4194304
lw_15:
  ds_read_b32 v15, v10 offset:6144
  s_waitcnt lgkmcnt(0)
  v_cmp_gt_u32 vcc, s44, v15
  s_cbranch_vccz lwd_16
  s_sleep 1
  s_sub_u32 s78, s78, 1
  s_cbranch_scc0 lw_15

lwd_16:
  s_branch c_la_back0
c_la_slow1:
  s_cmp_eq_u32 s45, 7
  s_cbranch_scc1 c_la_back1
  s_add_u32 s44, s45, 1

  s_mov_b32 s78, 4194304
lw_17:
  ds_read_b32 v15, v10 offset:6144
  s_waitcnt lgkmcnt(0)
  v_cmp_gt_u32 vcc, s44, v15
  s_cbranch_vccz lwd_18
  s_sleep 1
  s_sub_u32 s78, s78, 1
  s_cbranch_scc0 lw_17

lwd_18:
  s_branch c_la_back1
c_lb_rare:
  s_cmp_lg_u32 s45, 2
  s_cbranch_scc1 c_lb_r1

  v_mov_b32 v25, 1
  ds_write_b32 v9, v25 offset:6192
  s_waitcnt vmcnt(0)
  v_mov_b32 v26, 11
  ds_write_b32 v9, v26 offset:6144
  s_waitcnt lgkmcnt(0)
  s_branch c_lb_go
c_lb_r1:
  s_mov_b32 s78, 4194304
lw_19:
  ds_read_b32 v15, v10 offset:6144
  s_waitcnt lgkmcnt(0)
  v_cmp_gt_u32 vcc, 11, v15
  s_cbranch_vccz lwd_20
  s_sleep 1
  s_sub_u32 s78, s78, 1
  s_cbranch_scc0 lw_19

lwd_20:
  s_branch c_lb_go
c_done:
  s_mul_i32 s42, s37, 37
  s_lshr_b32 s42, s42, 8
  s_mul_i32 s43, s42, 7
  s_sub_u32 s47, s37, s43
  s_lshl_b32 s46, s36, 2
  s_add_u32 s46, s46, s42
  s_lshl_b32 s46, s46, 1

  v_and_b32 v15, 3, v1
  s_mul_i32 s42, s36, 28
  s_add_u32 s42, s42, s37
  s_lshl_b32 s42, s42, 2
  s_add_u32 s42, s42, s39
  s_lshl_b32 s42, s42, 2
  v_add_u32 v15, s42, v15
  v_lshlrev_b32 v15, 3, v15
  v_add_u32 v15, 17956864, v15
  s_and_b32 s42, s39, 1
  s_add_u32 s46, s46, s42
  s_mul_i32 s42, s46, 147456
  s_add_u32 s42, s42, 7340032
  v_add_u32 v3, s42, v2
  s_xor_b32 s42, s46, 1
  s_mul_i32 s42, s42, 147456
  s_add_u32 s42, s42, 7340032
  v_add_u32 v4, s42, v2
  s_mul_i32 s48, s39, 28672
  s_lshl_b32 s50, s39, 14
  s_add_u32 s50, s50, 90112

  v_lshrrev_b32 v12, 3, v1
  v_bfe_u32 v13, v1, 4, 1
  v_lshlrev_b32 v13, 2, v13
  v_and_b32 v14, 7, v1
  v_xor_b32 v14, v14, v13
  v_lshlrev_b32 v14, 4, v14
  s_movk_i32 s42, 896
  v_mad_u32_u24 v5, v12, s42, v14
  s_mul_i32 s49, s39, 401408
  s_lshl_b32 s42, s47, 7
  s_add_u32 s49, s49, s42

  v_lshrrev_b32 v12, 5, v1
  v_bfe_u32 v13, v1, 2, 2
  v_lshl_add_u32 v12, v12, 2, v13
  v_lshlrev_b32 v6, 7, v12
  v_bfe_u32 v13, v1, 3, 1
  s_lshr_b32 s42, s39, 1
  v_xor_b32 v13, s42, v13
  v_lshl_add_u32 v6, v13, 6, v6
  v_bfe_u32 v13, v1, 4, 1
  v_lshl_add_u32 v6, v13, 5, v6
  v_and_b32 v13, 3, v1
  v_lshl_add_u32 v6, v13, 3, v6
  v_xor_b32 v7, 64, v6
  v_add_u32 v6, s50, v6
  v_add_u32 v7, s50, v7
  s_lshl_b32 s47, s47, 1
  s_add_u32 s47, s47, s42

  s_mov_b32 s28, s8
  s_mov_b32 s29, s9
  s_mov_b32 s30, 401408

  s_mov_b32 s24, s4
  s_mov_b32 s25, s5
  s_mov_b32 s26, 1835008

  s_mov_b32 s32, s16
  s_mov_b32 s33, s17
  s_mov_b32 s34, 1835008

  s_mul_i32 s51, s39, 100352
  s_lshr_b32 s42, s47, 1
  s_lshl_b32 s42, s42, 7
  s_add_u32 s51, s51, s42

  s_add_u32 m0, s50, 0
  s_add_u32 s42, s51, 0
  buffer_load_dwordx4 v5, s[28:31], s42 offen lds
  s_add_u32 s42, s51, 6144
  buffer_load_dwordx4 v5, s[28:31], s42 offen offset:1024 lds
  s_add_u32 m0, s50, 2048
  s_add_u32 s42, s51, 14336
  buffer_load_dwordx4 v5, s[28:31], s42 offen lds
  s_add_u32 s42, s51, 20480
  buffer_load_dwordx4 v5, s[28:31], s42 offen offset:1024 lds
  s_add_u32 m0, s50, 4096
  s_add_u32 s42, s51, 25088
  buffer_load_dwordx4 v5, s[28:31], s42 offen lds
  s_add_u32 s42, s51, 31232
  buffer_load_dwordx4 v5, s[28:31], s42 offen offset:1024 lds
  s_add_u32 m0, s50, 6144
  s_add_u32 s42, s51, 39424
  buffer_load_dwordx4 v5, s[28:31], s42 offen lds
  s_add_u32 s42, s51, 45568
  buffer_load_dwordx4 v5, s[28:31], s42 offen offset:1024 lds
  s_add_u32 m0, s50, 8192
  s_add_u32 s42, s51, 50176
  buffer_load_dwordx4 v5, s[28:31], s42 offen lds
  s_add_u32 s42, s51, 56320
  buffer_load_dwordx4 v5, s[28:31], s42 offen offset:1024 lds
  s_add_u32 m0, s50, 10240
  s_add_u32 s42, s51, 64512
  buffer_load_dwordx4 v5, s[28:31], s42 offen lds
  s_add_u32 s42, s51, 70656
  buffer_load_dwordx4 v5, s[28:31], s42 offen offset:1024 lds
  s_add_u32 m0, s50, 12288
  s_add_u32 s42, s51, 75264
  buffer_load_dwordx4 v5, s[28:31], s42 offen lds
  s_add_u32 s42, s51, 81408
  buffer_load_dwordx4 v5, s[28:31], s42 offen offset:1024 lds
  s_add_u32 m0, s50, 14336
  s_add_u32 s42, s51, 89600
  buffer_load_dwordx4 v5, s[28:31], s42 offen lds
  s_add_u32 s42, s51, 95744
  buffer_load_dwordx4 v5, s[28:31], s42 offen offset:1024 lds
  v_add_u32 v208, 32768, v15
  v_and_b32 v220, 31, v1
  s_lshl_b32 s42, s46, 5
  v_add_u32 v220, s42, v220
  s_movk_i32 s42, 896
  v_mul_lo_u32 v220, v220, s42
  v_lshrrev_b32 v12, 5, v1
  v_lshl_add_u32 v8, v12, 3, v220
  v_lshl_add_u32 v220, v12, 4, v220
  s_lshl_b32 s47, s47, 6

  buffer_load_dwordx2 v[212:213], v8, s[24:27], s47 offen offset:0
  buffer_load_dwordx2 v[214:215], v8, s[24:27], s47 offen offset:16
  buffer_load_dwordx2 v[216:217], v8, s[24:27], s47 offen offset:32
  buffer_load_dwordx2 v[218:219], v8, s[24:27], s47 offen offset:48
  s_lshr_b32 s44, s40, 2
  s_mul_i32 s42, s44, 1792
  s_lshl_b32 s43, s41, 3
  s_add_u32 s42, s42, s43
  s_add_u32 s42, s42, 17956864
  v_lshlrev_b32 v16, 7, v1
  v_add_u32 v16, s42, v16
  v_cmp_lt_u32 vcc, 13, v1
  v_mov_b32 v17, 0x40000000
  s_nop 0
  v_cndmask_b32 v16, v16, v17, vcc

  s_waitcnt vmcnt(20)

  s_lshl_b32 s78, s39, 2
  v_mov_b32 v13, 1
  v_subrev_u32 v12, s78, v9
  ds_add_rtn_u32 v13, v12, v13 offset:6212
  v_mov_b32 v12, s76
  s_waitcnt lgkmcnt(0)
  v_readfirstlane_b32 s78, v13
  v_mov_b32 v13, s77
  s_cmp_lg_u32 s78, 3
  s_cbranch_scc1 pub_21
  buffer_store_dwordx2 v[12:13], v16, s[20:23], 0 offen sc1

pub_21:
  s_cmp_ge_u32 s37, 28
  s_cbranch_scc1 k_end

  s_waitcnt vmcnt(0)
  ds_read_b64_tr_b16 v[16:17], v6 offset:0
  ds_read_b64_tr_b16 v[18:19], v6 offset:1024
  ds_read_b64_tr_b16 v[20:21], v7 offset:0
  ds_read_b64_tr_b16 v[22:23], v7 offset:1024
  ds_read_b64_tr_b16 v[24:25], v6 offset:2048
  ds_read_b64_tr_b16 v[26:27], v6 offset:3072
  ds_read_b64_tr_b16 v[28:29], v7 offset:2048
  ds_read_b64_tr_b16 v[30:31], v7 offset:3072
  s_waitcnt lgkmcnt(0)
  ds_read_b64_tr_b16 v[32:33], v6 offset:4096
  ds_read_b64_tr_b16 v[34:35], v6 offset:5120
  ds_read_b64_tr_b16 v[36:37], v7 offset:4096
  ds_read_b64_tr_b16 v[38:39], v7 offset:5120
  ds_read_b64_tr_b16 v[40:41], v6 offset:6144
  ds_read_b64_tr_b16 v[42:43], v6 offset:7168
  ds_read_b64_tr_b16 v[44:45], v7 offset:6144
  ds_read_b64_tr_b16 v[46:47], v7 offset:7168
  s_waitcnt lgkmcnt(0)
  ds_read_b64_tr_b16 v[48:49], v6 offset:8192
  ds_read_b64_tr_b16 v[50:51], v6 offset:9216
  ds_read_b64_tr_b16 v[52:53], v7 offset:8192
  ds_read_b64_tr_b16 v[54:55], v7 offset:9216
  ds_read_b64_tr_b16 v[56:57], v6 offset:10240
  ds_read_b64_tr_b16 v[58:59], v6 offset:11264
  ds_read_b64_tr_b16 v[60:61], v7 offset:10240
  ds_read_b64_tr_b16 v[62:63], v7 offset:11264
  s_waitcnt lgkmcnt(0)
  ds_read_b64_tr_b16 v[64:65], v6 offset:12288
  ds_read_b64_tr_b16 v[66:67], v6 offset:13312
  ds_read_b64_tr_b16 v[68:69], v7 offset:12288
  ds_read_b64_tr_b16 v[70:71], v7 offset:13312
  ds_read_b64_tr_b16 v[72:73], v6 offset:14336
  ds_read_b64_tr_b16 v[74:75], v6 offset:15360
  ds_read_b64_tr_b16 v[76:77], v7 offset:14336
  ds_read_b64_tr_b16 v[78:79], v7 offset:15360
  s_waitcnt lgkmcnt(0)
  v_lshlrev_b32 v12, 16, v212
  v_and_b32 v13, 0xffff0000, v212
  v_add_f32 v80, v80, v12
  v_add_f32 v81, v81, v13
  v_lshlrev_b32 v12, 16, v213
  v_and_b32 v13, 0xffff0000, v213
  v_add_f32 v82, v82, v12
  v_add_f32 v83, v83, v13
  v_lshlrev_b32 v12, 16, v214
  v_and_b32 v13, 0xffff0000, v214
  v_add_f32 v84, v84, v12
  v_add_f32 v85, v85, v13
  v_lshlrev_b32 v12, 16, v215
  v_and_b32 v13, 0xffff0000, v215
  v_add_f32 v86, v86, v12
  v_add_f32 v87, v87, v13
  v_lshlrev_b32 v12, 16, v216
  v_and_b32 v13, 0xffff0000, v216
  v_add_f32 v88, v88, v12
  v_add_f32 v89, v89, v13
  v_lshlrev_b32 v12, 16, v217
  v_and_b32 v13, 0xffff0000, v217
  v_add_f32 v90, v90, v12
  v_add_f32 v91, v91, v13
  v_lshlrev_b32 v12, 16, v218
  v_and_b32 v13, 0xffff0000, v218
  v_add_f32 v92, v92, v12
  v_add_f32 v93, v93, v13
  v_lshlrev_b32 v12, 16, v219
  v_and_b32 v13, 0xffff0000, v219
  v_add_f32 v94, v94, v12
  v_add_f32 v95, v95, v13
  s_mov_b32 s28, s14
  s_mov_b32 s29, s15
  s_mov_b32 s30, 1605632

  s_mul_i32 s52, s37, 1
  s_and_b32 s52, s52, 3
  s_mul_i32 s42, s52, 7168
  s_add_u32 s48, s48, s42
  s_mul_i32 s42, s52, 100352
  s_add_u32 s49, s49, s42

  s_add_u32 m0, s50, 0
  s_add_u32 s42, s49, 6144
  buffer_load_dwordx4 v5, s[28:31], s49 offen lds
  buffer_load_dwordx4 v5, s[28:31], s42 offen offset:1024 lds
  s_add_u32 s49, s49, 14336
  s_add_u32 m0, s50, 2048
  s_add_u32 s42, s49, 6144
  buffer_load_dwordx4 v5, s[28:31], s49 offen lds
  buffer_load_dwordx4 v5, s[28:31], s42 offen offset:1024 lds
  s_add_u32 s49, s49, 14336
  s_add_u32 m0, s50, 4096
  s_add_u32 s42, s49, 6144
  buffer_load_dwordx4 v5, s[28:31], s49 offen lds
  buffer_load_dwordx4 v5, s[28:31], s42 offen offset:1024 lds
  s_add_u32 s49, s49, 14336
  s_add_u32 m0, s50, 6144
  s_add_u32 s42, s49, 6144
  buffer_load_dwordx4 v5, s[28:31], s49 offen lds
  buffer_load_dwordx4 v5, s[28:31], s42 offen offset:1024 lds
  s_add_u32 s49, s49, 14336
  s_add_u32 m0, s50, 8192
  s_add_u32 s42, s49, 6144
  buffer_load_dwordx4 v5, s[28:31], s49 offen lds
  buffer_load_dwordx4 v5, s[28:31], s42 offen offset:1024 lds
  s_add_u32 s49, s49, 14336
  s_add_u32 m0, s50, 10240
  s_add_u32 s42, s49, 6144
  buffer_load_dwordx4 v5, s[28:31], s49 offen lds
  buffer_load_dwordx4 v5, s[28:31], s42 offen offset:1024 lds
  s_add_u32 s49, s49, 14336
  s_add_u32 m0, s50, 12288
  s_add_u32 s42, s49, 6144
  buffer_load_dwordx4 v5, s[28:31], s49 offen lds
  buffer_load_dwordx4 v5, s[28:31], s42 offen offset:1024 lds
  s_add_u32 s49, s49, 14336
  s_mov_b32 s43, 0x40000000
  s_mov_b32 s78, 524288
pf_22:
  buffer_load_dwordx2 v[12:13], v15, s[20:23], 0 offen sc1
  s_waitcnt vmcnt(0)
  v_cmp_ne_u64 vcc, s[76:77], v[12:13]
  s_cbranch_vccz pfd_23
  s_sleep 3
  s_sub_u32 s78, s78, 1
  s_cbranch_scc0 pf_22

pfd_23:
g_pre:
  buffer_load_dwordx4 v[144:147], v3, s[20:23], s48 offen sc1
  buffer_load_dwordx4 v[148:151], v4, s[20:23], s48 offen sc1
  s_add_u32 s48, s48, 1024
  buffer_load_dwordx4 v[152:155], v3, s[20:23], s48 offen sc1
  buffer_load_dwordx4 v[156:159], v4, s[20:23], s48 offen sc1
  s_add_u32 s48, s48, 1024
  buffer_load_dwordx4 v[160:163], v3, s[20:23], s48 offen sc1
  buffer_load_dwordx4 v[164:167], v4, s[20:23], s48 offen sc1
  s_add_u32 s48, s48, 1024
  buffer_load_dwordx4 v[168:171], v3, s[20:23], s48 offen sc1
  buffer_load_dwordx4 v[172:175], v4, s[20:23], s48 offen sc1
  s_add_u32 s48, s48, 1024
  buffer_load_dwordx4 v[176:179], v3, s[20:23], s48 offen sc1
  buffer_load_dwordx4 v[180:183], v4, s[20:23], s48 offen sc1
  s_add_u32 s48, s48, 1024
  buffer_load_dwordx4 v[184:187], v3, s[20:23], s48 offen sc1
  buffer_load_dwordx4 v[188:191], v4, s[20:23], s48 offen sc1
  s_add_u32 s48, s48, 1024
  buffer_load_dwordx4 v[192:195], v3, s[20:23], s48 offen sc1
  buffer_load_dwordx4 v[196:199], v4, s[20:23], s48 offen sc1
  s_add_u32 s48, s48, 1024
  s_mov_b32 s45, 0
  s_setprio 2
g_loop:
  s_add_u32 s52, s52, 1
  s_cmp_eq_u32 s52, 4
  s_cselect_b32 s42, 28672, 0
  s_cselect_b32 s43, 401408, 0
  s_sub_u32 s48, s48, s42
  s_sub_u32 s49, s49, s43

  s_waitcnt vmcnt(12)
  ds_read_b64_tr_b16 v[224:225], v6 offset:0
  ds_read_b64_tr_b16 v[226:227], v6 offset:1024
  ds_read_b64_tr_b16 v[228:229], v7 offset:0
  ds_read_b64_tr_b16 v[230:231], v7 offset:1024
  s_waitcnt lgkmcnt(0)
  s_setprio 0
  v_mfma_f32_32x32x16_bf16 v[80:95], v[224:227], v[144:147], v[80:95]
  v_mfma_f32_32x32x16_bf16 v[96:111], v[224:227], v[148:151], v[96:111]
  v_mfma_f32_32x32x16_bf16 v[112:127], v[228:231], v[144:147], v[112:127]
  v_mfma_f32_32x32x16_bf16 v[128:143], v[228:231], v[148:151], v[128:143]
  s_setprio 2
  s_cmp_eq_u32 s45, 3
  s_cbranch_scc1 g_nl0
  s_add_u32 m0, s50, 0
  s_add_u32 s42, s49, 6144
  buffer_load_dwordx4 v5, s[28:31], s49 offen lds
  buffer_load_dwordx4 v5, s[28:31], s42 offen offset:1024 lds
  s_add_u32 s49, s49, 14336
  buffer_load_dwordx4 v[144:147], v3, s[20:23], s48 offen sc1
  buffer_load_dwordx4 v[148:151], v4, s[20:23], s48 offen sc1
  s_add_u32 s48, s48, 1024
g_nlb0:
  s_waitcnt vmcnt(12)
  ds_read_b64_tr_b16 v[224:225], v6 offset:2048
  ds_read_b64_tr_b16 v[226:227], v6 offset:3072
  ds_read_b64_tr_b16 v[228:229], v7 offset:2048
  ds_read_b64_tr_b16 v[230:231], v7 offset:3072
  s_waitcnt lgkmcnt(0)
  s_setprio 0
  v_mfma_f32_32x32x16_bf16 v[80:95], v[224:227], v[152:155], v[80:95]
  v_mfma_f32_32x32x16_bf16 v[96:111], v[224:227], v[156:159], v[96:111]
  v_mfma_f32_32x32x16_bf16 v[112:127], v[228:231], v[152:155], v[112:127]
  v_mfma_f32_32x32x16_bf16 v[128:143], v[228:231], v[156:159], v[128:143]
  s_setprio 2
  s_cmp_eq_u32 s45, 3
  s_cbranch_scc1 g_nl1
  s_add_u32 m0, s50, 2048
  s_add_u32 s42, s49, 6144
  buffer_load_dwordx4 v5, s[28:31], s49 offen lds
  buffer_load_dwordx4 v5, s[28:31], s42 offen offset:1024 lds
  s_add_u32 s49, s49, 14336
  buffer_load_dwordx4 v[152:155], v3, s[20:23], s48 offen sc1
  buffer_load_dwordx4 v[156:159], v4, s[20:23], s48 offen sc1
  s_add_u32 s48, s48, 1024
g_nlb1:
  s_waitcnt vmcnt(12)
  ds_read_b64_tr_b16 v[224:225], v6 offset:4096
  ds_read_b64_tr_b16 v[226:227], v6 offset:5120
  ds_read_b64_tr_b16 v[228:229], v7 offset:4096
  ds_read_b64_tr_b16 v[230:231], v7 offset:5120
  s_waitcnt lgkmcnt(0)
  s_setprio 0
  v_mfma_f32_32x32x16_bf16 v[80:95], v[224:227], v[160:163], v[80:95]
  v_mfma_f32_32x32x16_bf16 v[96:111], v[224:227], v[164:167], v[96:111]
  v_mfma_f32_32x32x16_bf16 v[112:127], v[228:231], v[160:163], v[112:127]
  v_mfma_f32_32x32x16_bf16 v[128:143], v[228:231], v[164:167], v[128:143]
  s_setprio 2
  s_cmp_eq_u32 s45, 3
  s_cbranch_scc1 g_nl2
  s_add_u32 m0, s50, 4096
  s_add_u32 s42, s49, 6144
  buffer_load_dwordx4 v5, s[28:31], s49 offen lds
  buffer_load_dwordx4 v5, s[28:31], s42 offen offset:1024 lds
  s_add_u32 s49, s49, 14336
  buffer_load_dwordx4 v[160:163], v3, s[20:23], s48 offen sc1
  buffer_load_dwordx4 v[164:167], v4, s[20:23], s48 offen sc1
  s_add_u32 s48, s48, 1024
g_nlb2:
  s_waitcnt vmcnt(12)
  ds_read_b64_tr_b16 v[224:225], v6 offset:6144
  ds_read_b64_tr_b16 v[226:227], v6 offset:7168
  ds_read_b64_tr_b16 v[228:229], v7 offset:6144
  ds_read_b64_tr_b16 v[230:231], v7 offset:7168
  s_waitcnt lgkmcnt(0)
  s_setprio 0
  v_mfma_f32_32x32x16_bf16 v[80:95], v[224:227], v[168:171], v[80:95]
  v_mfma_f32_32x32x16_bf16 v[96:111], v[224:227], v[172:175], v[96:111]
  v_mfma_f32_32x32x16_bf16 v[112:127], v[228:231], v[168:171], v[112:127]
  v_mfma_f32_32x32x16_bf16 v[128:143], v[228:231], v[172:175], v[128:143]
  s_setprio 2
  s_cmp_eq_u32 s45, 3
  s_cbranch_scc1 g_nl3
  s_add_u32 m0, s50, 6144
  s_add_u32 s42, s49, 6144
  buffer_load_dwordx4 v5, s[28:31], s49 offen lds
  buffer_load_dwordx4 v5, s[28:31], s42 offen offset:1024 lds
  s_add_u32 s49, s49, 14336
  buffer_load_dwordx4 v[168:171], v3, s[20:23], s48 offen sc1
  buffer_load_dwordx4 v[172:175], v4, s[20:23], s48 offen sc1
  s_add_u32 s48, s48, 1024
g_nlb3:
  s_waitcnt vmcnt(12)
  ds_read_b64_tr_b16 v[224:225], v6 offset:8192
  ds_read_b64_tr_b16 v[226:227], v6 offset:9216
  ds_read_b64_tr_b16 v[228:229], v7 offset:8192
  ds_read_b64_tr_b16 v[230:231], v7 offset:9216
  s_waitcnt lgkmcnt(0)
  s_setprio 0
  v_mfma_f32_32x32x16_bf16 v[80:95], v[224:227], v[176:179], v[80:95]
  v_mfma_f32_32x32x16_bf16 v[96:111], v[224:227], v[180:183], v[96:111]
  v_mfma_f32_32x32x16_bf16 v[112:127], v[228:231], v[176:179], v[112:127]
  v_mfma_f32_32x32x16_bf16 v[128:143], v[228:231], v[180:183], v[128:143]
  s_setprio 2
  s_cmp_eq_u32 s45, 3
  s_cbranch_scc1 g_nl4
  s_add_u32 m0, s50, 8192
  s_add_u32 s42, s49, 6144
  buffer_load_dwordx4 v5, s[28:31], s49 offen lds
  buffer_load_dwordx4 v5, s[28:31], s42 offen offset:1024 lds
  s_add_u32 s49, s49, 14336
  buffer_load_dwordx4 v[176:179], v3, s[20:23], s48 offen sc1
  buffer_load_dwordx4 v[180:183], v4, s[20:23], s48 offen sc1
  s_add_u32 s48, s48, 1024
g_nlb4:
  s_waitcnt vmcnt(12)
  ds_read_b64_tr_b16 v[224:225], v6 offset:10240
  ds_read_b64_tr_b16 v[226:227], v6 offset:11264
  ds_read_b64_tr_b16 v[228:229], v7 offset:10240
  ds_read_b64_tr_b16 v[230:231], v7 offset:11264
  s_waitcnt lgkmcnt(0)
  s_setprio 0
  v_mfma_f32_32x32x16_bf16 v[80:95], v[224:227], v[184:187], v[80:95]
  v_mfma_f32_32x32x16_bf16 v[96:111], v[224:227], v[188:191], v[96:111]
  v_mfma_f32_32x32x16_bf16 v[112:127], v[228:231], v[184:187], v[112:127]
  v_mfma_f32_32x32x16_bf16 v[128:143], v[228:231], v[188:191], v[128:143]
  s_setprio 2
  s_cmp_eq_u32 s45, 3
  s_cbranch_scc1 g_nl5
  s_add_u32 m0, s50, 10240
  s_add_u32 s42, s49, 6144
  buffer_load_dwordx4 v5, s[28:31], s49 offen lds
  buffer_load_dwordx4 v5, s[28:31], s42 offen offset:1024 lds
  s_add_u32 s49, s49, 14336
  buffer_load_dwordx4 v[184:187], v3, s[20:23], s48 offen sc1
  buffer_load_dwordx4 v[188:191], v4, s[20:23], s48 offen sc1
  s_add_u32 s48, s48, 1024
g_nlb5:
  s_waitcnt vmcnt(12)
  ds_read_b64_tr_b16 v[224:225], v6 offset:12288
  ds_read_b64_tr_b16 v[226:227], v6 offset:13312
  ds_read_b64_tr_b16 v[228:229], v7 offset:12288
  ds_read_b64_tr_b16 v[230:231], v7 offset:13312
  s_waitcnt lgkmcnt(0)
  s_setprio 0
  v_mfma_f32_32x32x16_bf16 v[80:95], v[224:227], v[192:195], v[80:95]
  v_mfma_f32_32x32x16_bf16 v[96:111], v[224:227], v[196:199], v[96:111]
  v_mfma_f32_32x32x16_bf16 v[112:127], v[228:231], v[192:195], v[112:127]
  v_mfma_f32_32x32x16_bf16 v[128:143], v[228:231], v[196:199], v[128:143]
  s_setprio 2
  s_cmp_eq_u32 s45, 3
  s_cbranch_scc1 g_nl6
  s_add_u32 m0, s50, 12288
  s_add_u32 s42, s49, 6144
  buffer_load_dwordx4 v5, s[28:31], s49 offen lds
  buffer_load_dwordx4 v5, s[28:31], s42 offen offset:1024 lds
  s_add_u32 s49, s49, 14336
  buffer_load_dwordx4 v[192:195], v3, s[20:23], s48 offen sc1
  buffer_load_dwordx4 v[196:199], v4, s[20:23], s48 offen sc1
  s_add_u32 s48, s48, 1024
g_nlb6:
  s_add_u32 s45, s45, 1
  s_cmp_lt_u32 s45, 4
  s_cbranch_scc1 g_loop

  s_branch g_p3
g_nl0:
  s_branch g_nlb0
g_nl1:
  s_branch g_nlb1
g_nl2:
  s_branch g_nlb2
g_nl3:
  s_waitcnt vmcnt(8)
  s_branch g_nlb3
g_nl4:
  s_waitcnt vmcnt(4)
  s_branch g_nlb4
g_nl5:
  s_waitcnt vmcnt(0)
  s_branch g_nlb5
g_nl6:
  s_waitcnt vmcnt(0)
  s_branch g_nlb6
g_p3:
  s_setprio 2
  s_waitcnt vmcnt(0)
  s_lshl_b32 s48, s39, 13
  s_add_u32 s48, s48, 114688
  s_add_u32 s43, s48, 4096

g_tail:
  s_mov_b32 s78, 4194304
lw_24:
  ds_read_b32 v12, v10 offset:6176
  s_waitcnt lgkmcnt(0)
  v_cmp_gt_u32 vcc, 2, v12
  s_cbranch_vccz lwd_25
  s_sleep 2
  s_sub_u32 s78, s78, 1
  s_cbranch_scc0 lw_24

lwd_25:
  s_mov_b32 s78, 524288
pf_26:
  buffer_load_dwordx2 v[12:13], v208, s[20:23], 0 offen sc1
  s_waitcnt vmcnt(0)
  v_cmp_ne_u64 vcc, s[76:77], v[12:13]
  s_cbranch_vccz pfd_27
  s_sleep 3
  s_sub_u32 s78, s78, 1
  s_cbranch_scc0 pf_26

pfd_27:
  buffer_load_dwordx4 v[144:147], v3, s[20:23], s48 offen offset:0 sc1
  buffer_load_dwordx4 v[148:151], v4, s[20:23], s48 offen offset:0 sc1
  buffer_load_dwordx4 v[152:155], v3, s[20:23], s48 offen offset:1024 sc1
  buffer_load_dwordx4 v[156:159], v4, s[20:23], s48 offen offset:1024 sc1
  buffer_load_dwordx4 v[160:163], v3, s[20:23], s48 offen offset:2048 sc1
  buffer_load_dwordx4 v[164:167], v4, s[20:23], s48 offen offset:2048 sc1
  buffer_load_dwordx4 v[168:171], v3, s[20:23], s48 offen offset:3072 sc1
  buffer_load_dwordx4 v[172:175], v4, s[20:23], s48 offen offset:3072 sc1
  buffer_load_dwordx4 v[176:179], v3, s[20:23], s43 offen offset:0 sc1
  buffer_load_dwordx4 v[180:183], v4, s[20:23], s43 offen offset:0 sc1
  buffer_load_dwordx4 v[184:187], v3, s[20:23], s43 offen offset:1024 sc1
  buffer_load_dwordx4 v[188:191], v4, s[20:23], s43 offen offset:1024 sc1
  buffer_load_dwordx4 v[192:195], v3, s[20:23], s43 offen offset:2048 sc1
  buffer_load_dwordx4 v[196:199], v4, s[20:23], s43 offen offset:2048 sc1
  buffer_load_dwordx4 v[200:203], v3, s[20:23], s43 offen offset:3072 sc1
  buffer_load_dwordx4 v[204:207], v4, s[20:23], s43 offen offset:3072 sc1
  s_waitcnt vmcnt(14)
  v_mfma_f32_32x32x16_bf16 v[80:95], v[16:19], v[144:147], v[80:95]
  v_mfma_f32_32x32x16_bf16 v[96:111], v[16:19], v[148:151], v[96:111]
  v_mfma_f32_32x32x16_bf16 v[112:127], v[20:23], v[144:147], v[112:127]
  v_mfma_f32_32x32x16_bf16 v[128:143], v[20:23], v[148:151], v[128:143]
  s_waitcnt vmcnt(12)
  v_mfma_f32_32x32x16_bf16 v[80:95], v[24:27], v[152:155], v[80:95]
  v_mfma_f32_32x32x16_bf16 v[96:111], v[24:27], v[156:159], v[96:111]
  v_mfma_f32_32x32x16_bf16 v[112:127], v[28:31], v[152:155], v[112:127]
  v_mfma_f32_32x32x16_bf16 v[128:143], v[28:31], v[156:159], v[128:143]
  s_waitcnt vmcnt(10)
  v_mfma_f32_32x32x16_bf16 v[80:95], v[32:35], v[160:163], v[80:95]
  v_mfma_f32_32x32x16_bf16 v[96:111], v[32:35], v[164:167], v[96:111]
  v_mfma_f32_32x32x16_bf16 v[112:127], v[36:39], v[160:163], v[112:127]
  v_mfma_f32_32x32x16_bf16 v[128:143], v[36:39], v[164:167], v[128:143]
  s_waitcnt vmcnt(8)
  v_mfma_f32_32x32x16_bf16 v[80:95], v[40:43], v[168:171], v[80:95]
  v_mfma_f32_32x32x16_bf16 v[96:111], v[40:43], v[172:175], v[96:111]
  v_mfma_f32_32x32x16_bf16 v[112:127], v[44:47], v[168:171], v[112:127]
  v_mfma_f32_32x32x16_bf16 v[128:143], v[44:47], v[172:175], v[128:143]
  s_waitcnt vmcnt(6)
  v_mfma_f32_32x32x16_bf16 v[80:95], v[48:51], v[176:179], v[80:95]
  v_mfma_f32_32x32x16_bf16 v[96:111], v[48:51], v[180:183], v[96:111]
  v_mfma_f32_32x32x16_bf16 v[112:127], v[52:55], v[176:179], v[112:127]
  v_mfma_f32_32x32x16_bf16 v[128:143], v[52:55], v[180:183], v[128:143]
  s_waitcnt vmcnt(4)
  v_mfma_f32_32x32x16_bf16 v[80:95], v[56:59], v[184:187], v[80:95]
  v_mfma_f32_32x32x16_bf16 v[96:111], v[56:59], v[188:191], v[96:111]
  v_mfma_f32_32x32x16_bf16 v[112:127], v[60:63], v[184:187], v[112:127]
  v_mfma_f32_32x32x16_bf16 v[128:143], v[60:63], v[188:191], v[128:143]
  s_waitcnt vmcnt(2)
  v_mfma_f32_32x32x16_bf16 v[80:95], v[64:67], v[192:195], v[80:95]
  v_mfma_f32_32x32x16_bf16 v[96:111], v[64:67], v[196:199], v[96:111]
  v_mfma_f32_32x32x16_bf16 v[112:127], v[68:71], v[192:195], v[112:127]
  v_mfma_f32_32x32x16_bf16 v[128:143], v[68:71], v[196:199], v[128:143]
  s_waitcnt vmcnt(0)
  v_mfma_f32_32x32x16_bf16 v[80:95], v[72:75], v[200:203], v[80:95]
  v_mfma_f32_32x32x16_bf16 v[96:111], v[72:75], v[204:207], v[96:111]
  v_mfma_f32_32x32x16_bf16 v[112:127], v[76:79], v[200:203], v[112:127]
  v_mfma_f32_32x32x16_bf16 v[128:143], v[76:79], v[204:207], v[128:143]
  s_nop 7
  s_nop 3
  v_add_u32 v12, s50, v2
  ds_write_b128 v12, v[96:99] offset:0
  ds_write_b128 v12, v[100:103] offset:1024
  ds_write_b128 v12, v[104:107] offset:2048
  ds_write_b128 v12, v[108:111] offset:3072
  ds_write_b128 v12, v[112:115] offset:4096
  ds_write_b128 v12, v[116:119] offset:5120
  ds_write_b128 v12, v[120:123] offset:6144
  ds_write_b128 v12, v[124:127] offset:7168
  ds_write_b128 v12, v[128:131] offset:8192
  ds_write_b128 v12, v[132:135] offset:9216
  ds_write_b128 v12, v[136:139] offset:10240
  ds_write_b128 v12, v[140:143] offset:11264
  s_waitcnt lgkmcnt(0)
  v_mov_b32 v12, 3
  ds_write_b32 v9, v12 offset:6192
  s_mov_b32 s78, 4194304
lw_28:
  ds_read_b32 v12, v10 offset:6192
  s_waitcnt lgkmcnt(0)
  v_cmp_gt_u32 vcc, 3, v12
  s_cbranch_vccz lwd_29
  s_sleep 0
  s_sub_u32 s78, s78, 1
  s_cbranch_scc0 lw_28

lwd_29:
g_tail2:
  s_xor_b32 s42, s39, 1
  s_lshl_b32 s42, s42, 14
  s_add_u32 s42, s42, 90112
  v_add_u32 v12, s42, v2

  ds_read_b128 v[144:147], v12 offset:0
  ds_read_b128 v[148:151], v12 offset:1024
  ds_read_b128 v[152:155], v12 offset:2048
  ds_read_b128 v[156:159], v12 offset:3072
  s_xor_b32 s42, s39, 2
  s_lshl_b32 s42, s42, 14
  s_add_u32 s42, s42, 94208
  v_add_u32 v12, s42, v2

  ds_read_b128 v[160:163], v12 offset:0
  ds_read_b128 v[164:167], v12 offset:1024
  ds_read_b128 v[168:171], v12 offset:2048
  ds_read_b128 v[172:175], v12 offset:3072
  s_xor_b32 s42, s39, 3
  s_lshl_b32 s42, s42, 14
  s_add_u32 s42, s42, 98304
  v_add_u32 v12, s42, v2

  ds_read_b128 v[176:179], v12 offset:0
  ds_read_b128 v[180:183], v12 offset:1024
  ds_read_b128 v[184:187], v12 offset:2048
  ds_read_b128 v[188:191], v12 offset:3072
  s_waitcnt lgkmcnt(11)
  v_add_f32 v80, v80, v144
  v_add_f32 v81, v81, v145
  v_add_f32 v82, v82, v146
  v_add_f32 v83, v83, v147
  s_waitcnt lgkmcnt(10)
  v_add_f32 v84, v84, v148
  v_add_f32 v85, v85, v149
  v_add_f32 v86, v86, v150
  v_add_f32 v87, v87, v151
  s_waitcnt lgkmcnt(9)
  v_add_f32 v88, v88, v152
  v_add_f32 v89, v89, v153
  v_add_f32 v90, v90, v154
  v_add_f32 v91, v91, v155
  s_waitcnt lgkmcnt(8)
  v_add_f32 v92, v92, v156
  v_add_f32 v93, v93, v157
  v_add_f32 v94, v94, v158
  v_add_f32 v95, v95, v159
  s_waitcnt lgkmcnt(7)
  v_add_f32 v80, v80, v160
  v_add_f32 v81, v81, v161
  v_add_f32 v82, v82, v162
  v_add_f32 v83, v83, v163
  s_waitcnt lgkmcnt(6)
  v_add_f32 v84, v84, v164
  v_add_f32 v85, v85, v165
  v_add_f32 v86, v86, v166
  v_add_f32 v87, v87, v167
  s_waitcnt lgkmcnt(5)
  v_add_f32 v88, v88, v168
  v_add_f32 v89, v89, v169
  v_add_f32 v90, v90, v170
  v_add_f32 v91, v91, v171
  s_waitcnt lgkmcnt(4)
  v_add_f32 v92, v92, v172
  v_add_f32 v93, v93, v173
  v_add_f32 v94, v94, v174
  v_add_f32 v95, v95, v175
  s_waitcnt lgkmcnt(3)
  v_add_f32 v80, v80, v176
  v_add_f32 v81, v81, v177
  v_add_f32 v82, v82, v178
  v_add_f32 v83, v83, v179
  s_waitcnt lgkmcnt(2)
  v_add_f32 v84, v84, v180
  v_add_f32 v85, v85, v181
  v_add_f32 v86, v86, v182
  v_add_f32 v87, v87, v183
  s_waitcnt lgkmcnt(1)
  v_add_f32 v88, v88, v184
  v_add_f32 v89, v89, v185
  v_add_f32 v90, v90, v186
  v_add_f32 v91, v91, v187
  s_waitcnt lgkmcnt(0)
  v_add_f32 v92, v92, v188
  v_add_f32 v93, v93, v189
  v_add_f32 v94, v94, v190
  v_add_f32 v95, v95, v191
  v_cvt_pk_bf16_f32 v144, v80, v81
  v_cvt_pk_bf16_f32 v145, v82, v83
  v_cvt_pk_bf16_f32 v146, v84, v85
  v_cvt_pk_bf16_f32 v147, v86, v87
  v_cvt_pk_bf16_f32 v148, v88, v89
  v_cvt_pk_bf16_f32 v149, v90, v91
  v_cvt_pk_bf16_f32 v150, v92, v93
  v_cvt_pk_bf16_f32 v151, v94, v95
  s_nop 1
  v_permlane32_swap_b32 v144, v146
  v_permlane32_swap_b32 v145, v147
  v_permlane32_swap_b32 v148, v150
  v_permlane32_swap_b32 v149, v151
  s_nop 1
  buffer_store_dwordx4 v[144:147], v220, s[32:35], s47 offen offset:0
  buffer_store_dwordx4 v[148:151], v220, s[32:35], s47 offen offset:32
  s_endpgm
x_attn:
  s_and_b32 s46, s37, 1
  s_lshl_b32 s42, s36, 1
  s_add_u32 s46, s46, s42
  s_lshr_b32 s47, s37, 1
  s_lshl_b32 s48, s46, 18
  s_add_u32 s48, s48, 2097152
  s_lshl_b32 s51, s39, 12
  v_lshrrev_b32 v7, 5, v1
  v_add_u32 v5, s51, v2
  v_bfe_u32 v12, v1, 4, 1
  v_lshlrev_b32 v6, 10, v12
  v_and_b32 v12, 1, v1
  v_lshl_add_u32 v6, v12, 9, v6
  v_bfe_u32 v12, v1, 1, 1
  v_lshl_add_u32 v6, v12, 3, v6
  v_bfe_u32 v12, v1, 2, 2
  v_lshl_add_u32 v12, v7, 2, v12
  v_lshl_add_u32 v6, v12, 4, v6
  v_add_u32 v6, s51, v6
  v_add_u32 v6, 2048, v6
  v_sub_u32 v8, v7, 1
  v_sub_u32 v7, 0, v7

  s_lshl_b32 s42, s46, 4
  s_add_u32 s42, s42, s47
  s_lshl_b32 s42, s42, 9
  s_add_u32 s42, s42, 17825792
  s_lshl_b32 s43, s47, 3
  s_add_u32 s43, s43, s42
  v_and_b32 v208, 1, v1
  v_lshlrev_b32 v208, 7, v208
  v_add_u32 v208, s43, v208
  s_lshl_b32 s43, s39, 5
  s_add_u32 s43, s43, s42
  s_add_u32 s43, s43, 128
  v_bfe_u32 v209, v1, 2, 1
  v_lshlrev_b32 v209, 7, v209
  v_and_b32 v12, 3, v1
  v_lshl_add_u32 v209, v12, 3, v209
  s_mov_b64 exec, 0xff
  v_add_u32 v208, s43, v209
  s_mov_b64 exec, -1

  s_mul_i32 s42, s47, 1792
  s_lshl_b32 s43, s46, 3
  s_add_u32 s42, s42, s43
  s_add_u32 s42, s42, 17989632
  v_lshlrev_b32 v210, 7, v1
  v_add_u32 v210, s42, v210
  v_cmp_lt_u32 vcc, 13, v1
  v_mov_b32 v211, 0x40000000
  s_nop 0
  v_cndmask_b32 v210, v210, v211, vcc

  v_mov_b32 v3, v5
  v_mov_b32 v4, v6
  s_waitcnt lgkmcnt(0)
  v_mov_b32 v152, 0
  v_mov_b32 v184, 0
  v_mov_b32 v153, 0
  v_mov_b32 v185, 0
  v_mov_b32 v154, 0
  v_mov_b32 v186, 0
  v_mov_b32 v155, 0
  v_mov_b32 v187, 0
  v_mov_b32 v156, 0
  v_mov_b32 v188, 0
  v_mov_b32 v157, 0
  v_mov_b32 v189, 0
  v_mov_b32 v158, 0
  v_mov_b32 v190, 0
  v_mov_b32 v159, 0
  v_mov_b32 v191, 0
  s_lshl_b32 s42, s39, 16
  s_add_u32 s42, s48, s42
  v_add_u32 v212, s42, v2
  s_mul_i32 s50, s47, 4096
  s_mov_b32 s53, 0xffff
  s_waitcnt vmcnt(0)
  v_readfirstlane_b32 s76, v18
  v_readfirstlane_b32 s77, v19
  s_min_u32 s42, s76, s77
  s_cmp_lg_u32 s42, 0
  s_cbranch_scc1 a_tagok

  s_mov_b32 s78, 524288
tg_30:
  buffer_load_dwordx2 v[14:15], v0, s[32:35], 0 offen sc1
  s_waitcnt vmcnt(0)
  v_readfirstlane_b32 s76, v14
  v_readfirstlane_b32 s77, v15
  s_cbranch_execz tgd_31
  s_min_u32 s42, s76, s77
  s_cmp_lg_u32 s42, 0
  s_cbranch_scc1 tgd_31
  s_sub_u32 s78, s78, 1
  s_cbranch_scc0 tg_30

tgd_31:
a_tagok:
  s_lshl_b32 s78, s39, 2
  v_mov_b32 v15, 1
  v_subrev_u32 v14, s78, v9
  ds_add_rtn_u32 v15, v14, v15 offset:6208
  v_mov_b32 v14, s76
  s_waitcnt lgkmcnt(0)
  v_readfirstlane_b32 s78, v15
  v_mov_b32 v15, s77
  s_cmp_lg_u32 s78, 3
  s_cbranch_scc1 pub_32
  buffer_store_dwordx2 v[14:15], v17, s[20:23], 0 offen sc1

pub_32:
  s_setprio 3
  s_mov_b32 s78, 4194304
lw_33:
  ds_read_b32 v12, v10 offset:6144
  s_waitcnt lgkmcnt(0)
  v_cmp_gt_u32 vcc, 7, v12
  s_cbranch_vccz lwd_34
  s_sleep 1
  s_sub_u32 s78, s78, 1
  s_cbranch_scc0 lw_33

lwd_34:
  s_sleep 12
  s_mov_b32 s78, 524288
pf_35:
  buffer_load_dwordx2 v[14:15], v208, s[20:23], 0 offen sc1
  s_waitcnt vmcnt(0)
  v_cmp_ne_u64 vcc, s[76:77], v[14:15]
  s_cbranch_vccz pfd_36
  s_sleep 3
  s_sub_u32 s78, s78, 1
  s_cbranch_scc0 pf_35

pfd_36:
a_pro:
  s_lshl_b32 s42, s47, 14
  s_add_u32 s42, s42, s48
  buffer_load_dwordx4 v[168:171], v2, s[20:23], s42 offen sc1
  buffer_load_dwordx4 v[172:175], v2, s[20:23], s42 offen offset:1024 sc1
  s_lshl_b32 s43, s47, 2
  s_lshl_b32 s44, s46, 6
  s_add_u32 s43, s43, s44

  s_xor_b32 s42, s39, 0
  s_add_u32 s42, s42, s43
  s_lshl_b32 s42, s42, 11
  buffer_load_dwordx4 v[16:19], v2, s[20:23], s42 offen sc1
  buffer_load_dwordx4 v[20:23], v2, s[20:23], s42 offen offset:1024 sc1

  s_xor_b32 s42, s39, 1
  s_add_u32 s42, s42, s43
  s_lshl_b32 s42, s42, 11
  buffer_load_dwordx4 v[24:27], v2, s[20:23], s42 offen sc1
  buffer_load_dwordx4 v[28:31], v2, s[20:23], s42 offen offset:1024 sc1

  s_xor_b32 s42, s39, 2
  s_add_u32 s42, s42, s43
  s_lshl_b32 s42, s42, 11
  buffer_load_dwordx4 v[32:35], v2, s[20:23], s42 offen sc1
  buffer_load_dwordx4 v[36:39], v2, s[20:23], s42 offen offset:1024 sc1

  s_xor_b32 s42, s39, 3
  s_add_u32 s42, s42, s43
  s_lshl_b32 s42, s42, 11
  buffer_load_dwordx4 v[40:43], v2, s[20:23], s42 offen sc1
  buffer_load_dwordx4 v[44:47], v2, s[20:23], s42 offen offset:1024 sc1

  s_mov_b32 m0, s51
  s_nop 0

  buffer_load_dwordx4 v212, s[20:23], s50 offen offset:0 sc1 lds
  buffer_load_dwordx4 v212, s[20:23], s50 offen offset:1024 sc1 lds
  buffer_load_dwordx4 v212, s[20:23], s50 offen offset:2048 sc1 lds
  buffer_load_dwordx4 v212, s[20:23], s50 offen offset:3072 sc1 lds
  s_add_u32 m0, m0, 16384
  s_add_u32 s50, s50, 4096
  s_and_b32 s50, s50, s53
  buffer_load_dwordx4 v212, s[20:23], s50 offen offset:0 sc1 lds
  buffer_load_dwordx4 v212, s[20:23], s50 offen offset:1024 sc1 lds
  buffer_load_dwordx4 v212, s[20:23], s50 offen offset:2048 sc1 lds
  buffer_load_dwordx4 v212, s[20:23], s50 offen offset:3072 sc1 lds
  s_add_u32 m0, m0, 16384
  s_add_u32 s50, s50, 4096
  s_and_b32 s50, s50, s53
  s_waitcnt vmcnt(14)
  v_mfma_f32_32x32x16_bf16 v[48:63], v[168:171], v[16:19], 0
  v_mfma_f32_32x32x16_bf16 v[48:63], v[172:175], v[20:23], v[48:63]
  s_waitcnt vmcnt(12)
  v_mfma_f32_32x32x16_bf16 v[64:79], v[168:171], v[24:27], 0
  v_mfma_f32_32x32x16_bf16 v[64:79], v[172:175], v[28:31], v[64:79]
  s_waitcnt vmcnt(10)
  v_mfma_f32_32x32x16_bf16 v[80:95], v[168:171], v[32:35], 0
  v_mfma_f32_32x32x16_bf16 v[80:95], v[172:175], v[36:39], v[80:95]
  s_waitcnt vmcnt(8)
  v_mfma_f32_32x32x16_bf16 v[96:111], v[168:171], v[40:43], 0
  v_mfma_f32_32x32x16_bf16 v[96:111], v[172:175], v[44:47], v[96:111]
  s_nop 3
  v_max3_f32 v12, v48, v49, v50
  v_max3_f32 v12, v12, v51, v52
  v_max3_f32 v12, v12, v53, v54
  v_max3_f32 v12, v12, v55, v56
  v_max3_f32 v12, v12, v57, v58
  v_max3_f32 v12, v12, v59, v60
  v_max3_f32 v12, v12, v61, v62
  v_max_f32 v12, v12, v63
  v_mov_b32 v13, v12
  v_mfma_f32_32x32x16_bf16 v[48:63], v[152:155], v[152:155], 0
  s_nop 0
  v_permlane32_swap_b32 v12, v13
  s_nop 1
  v_max_f32 v12, v12, v13
  v_add_f32 v12, 0x429e0000, v12
  v_cvt_pk_bf16_f32 v12, -v12, 0
  v_and_b32 v12, v12, v7
  v_and_or_b32 v22, v22, v8, v12
  v_max3_f32 v14, v64, v65, v66
  v_max3_f32 v14, v14, v67, v68
  v_max3_f32 v14, v14, v69, v70
  v_max3_f32 v14, v14, v71, v72
  v_max3_f32 v14, v14, v73, v74
  v_max3_f32 v14, v14, v75, v76
  v_max3_f32 v14, v14, v77, v78
  v_max_f32 v14, v14, v79
  v_mov_b32 v15, v14
  v_mfma_f32_32x32x16_bf16 v[64:79], v[152:155], v[152:155], 0
  s_nop 0
  v_permlane32_swap_b32 v14, v15
  s_nop 1
  v_max_f32 v14, v14, v15
  v_add_f32 v14, 0x429e0000, v14
  v_cvt_pk_bf16_f32 v14, -v14, 0
  v_and_b32 v14, v14, v7
  v_and_or_b32 v30, v30, v8, v14
  s_mov_b32 s78, 4194304
lw_37:
  ds_read_b32 v12, v10 offset:6192
  s_waitcnt lgkmcnt(0)
  v_cmp_gt_u32 vcc, 1, v12
  s_cbranch_vccz lwd_38
  s_sleep 1
  s_sub_u32 s78, s78, 1
  s_cbranch_scc0 lw_37

lwd_38:
  buffer_load_dwordx4 v212, s[20:23], s50 offen offset:0 sc1 lds
  buffer_load_dwordx4 v212, s[20:23], s50 offen offset:1024 sc1 lds
  buffer_load_dwordx4 v212, s[20:23], s50 offen offset:2048 sc1 lds
  buffer_load_dwordx4 v212, s[20:23], s50 offen offset:3072 sc1 lds
  s_add_u32 m0, m0, 16384
  s_add_u32 s50, s50, 4096
  s_and_b32 s50, s50, s53
  buffer_load_dwordx4 v212, s[20:23], s50 offen offset:0 sc1 lds
  buffer_load_dwordx4 v212, s[20:23], s50 offen offset:1024 sc1 lds
  buffer_load_dwordx4 v212, s[20:23], s50 offen offset:2048 sc1 lds
  buffer_load_dwordx4 v212, s[20:23], s50 offen offset:3072 sc1 lds
  s_add_u32 s50, s50, 4096
  s_and_b32 s50, s50, s53
  v_max3_f32 v12, v80, v81, v82
  v_max3_f32 v12, v12, v83, v84
  v_max3_f32 v12, v12, v85, v86
  v_max3_f32 v12, v12, v87, v88
  v_max3_f32 v12, v12, v89, v90
  v_max3_f32 v12, v12, v91, v92
  v_max3_f32 v12, v12, v93, v94
  v_max_f32 v12, v12, v95
  v_mov_b32 v13, v12
  v_mfma_f32_32x32x16_bf16 v[80:95], v[152:155], v[152:155], 0
  s_nop 0
  v_permlane32_swap_b32 v12, v13
  s_nop 1
  v_max_f32 v12, v12, v13
  v_add_f32 v12, 0x429e0000, v12
  v_cvt_pk_bf16_f32 v12, -v12, 0
  v_and_b32 v12, v12, v7
  v_and_or_b32 v38, v38, v8, v12
  s_waitcnt vmcnt(12)
  ds_read_b128 v[160:163], v5 offset:0
  ds_read_b128 v[164:167], v5 offset:1024
  ds_read_b64_tr_b16 v[176:177], v6 offset:0
  ds_read_b64_tr_b16 v[178:179], v6 offset:128
  ds_read_b64_tr_b16 v[180:181], v6 offset:256
  ds_read_b64_tr_b16 v[182:183], v6 offset:384
  v_max3_f32 v14, v96, v97, v98
  v_max3_f32 v14, v14, v99, v100
  v_max3_f32 v14, v14, v101, v102
  v_max3_f32 v14, v14, v103, v104
  v_max3_f32 v14, v14, v105, v106
  v_max3_f32 v14, v14, v107, v108
  v_max3_f32 v14, v14, v109, v110
  v_max_f32 v14, v14, v111
  v_mov_b32 v15, v14
  v_mfma_f32_32x32x16_bf16 v[96:111], v[152:155], v[152:155], 0
  s_nop 0
  v_permlane32_swap_b32 v14, v15
  s_nop 1
  v_max_f32 v14, v14, v15
  v_add_f32 v14, 0x429e0000, v14
  v_cvt_pk_bf16_f32 v14, -v14, 0
  v_and_b32 v14, v14, v7
  v_and_or_b32 v46, v46, v8, v14
  s_mov_b32 s49, 0
  s_mov_b32 s45, 0
  s_waitcnt lgkmcnt(0)

  v_mfma_f32_32x32x16_bf16 v[112:127], v[160:163], v[16:19], 0
  v_mfma_f32_32x32x16_bf16 v[112:127], v[164:167], v[20:23], v[112:127]
  s_nop 7
  s_nop 3
  s_setprio 1
.p2align 6
a_loop:
  v_mfma_f32_32x32x16_bf16 v[128:143], v[160:163], v[24:27], 0
  v_exp_f32 v112, v112
  v_exp_f32 v113, v113
  v_exp_f32 v114, v114
  v_mfma_f32_32x32x16_bf16 v[128:143], v[164:167], v[28:31], v[128:143]
  v_exp_f32 v115, v115
  v_exp_f32 v116, v116
  v_exp_f32 v117, v117
  v_mfma_f32_32x32x16_bf16 v[96:111], v[184:187], v[152:155], v[96:111]
  s_add_u32 m0, s51, 0
  v_exp_f32 v118, v118
  v_exp_f32 v119, v119
  v_exp_f32 v120, v120
  v_mfma_f32_32x32x16_bf16 v[96:111], v[188:191], v[156:159], v[96:111]
  s_cmp_eq_u32 s45, 3
  s_cbranch_scc1 a_nd0
  s_setprio 3
  buffer_load_dwordx4 v212, s[20:23], s50 offen offset:0 sc1 lds
  buffer_load_dwordx4 v212, s[20:23], s50 offen offset:1024 sc1 lds
  buffer_load_dwordx4 v212, s[20:23], s50 offen offset:2048 sc1 lds
  buffer_load_dwordx4 v212, s[20:23], s50 offen offset:3072 sc1 lds
  s_setprio 1
  s_add_u32 s50, s50, 4096
  s_and_b32 s50, s50, s53
a_ndb0:
  v_exp_f32 v121, v121
  v_exp_f32 v122, v122
  v_exp_f32 v123, v123
  v_exp_f32 v124, v124
  v_exp_f32 v125, v125
  v_exp_f32 v126, v126
  v_exp_f32 v127, v127
  v_cvt_pk_bf16_f32 v144, v112, v113
  v_cvt_pk_bf16_f32 v145, v114, v115
  v_cvt_pk_bf16_f32 v146, v116, v117
  v_cvt_pk_bf16_f32 v147, v118, v119
  v_cvt_pk_bf16_f32 v148, v120, v121
  v_cvt_pk_bf16_f32 v149, v122, v123
  v_cvt_pk_bf16_f32 v150, v124, v125
  v_cvt_pk_bf16_f32 v151, v126, v127
  v_mfma_f32_32x32x16_bf16 v[112:127], v[160:163], v[32:35], 0
  v_exp_f32 v128, v128
  v_exp_f32 v129, v129
  v_exp_f32 v130, v130
  v_mfma_f32_32x32x16_bf16 v[112:127], v[164:167], v[36:39], v[112:127]
  v_exp_f32 v131, v131
  v_exp_f32 v132, v132
  v_exp_f32 v133, v133
  v_mfma_f32_32x32x16_bf16 v[48:63], v[176:179], v[144:147], v[48:63]
  v_exp_f32 v134, v134
  v_exp_f32 v135, v135
  v_exp_f32 v136, v136
  v_mfma_f32_32x32x16_bf16 v[48:63], v[180:183], v[148:151], v[48:63]
  s_waitcnt vmcnt(12)
  ds_read_b128 v[168:171], v5 offset:16384
  ds_read_b128 v[172:175], v5 offset:17408
  ds_read_b64_tr_b16 v[184:185], v6 offset:16384
  ds_read_b64_tr_b16 v[186:187], v6 offset:16512
  ds_read_b64_tr_b16 v[188:189], v6 offset:16640
  ds_read_b64_tr_b16 v[190:191], v6 offset:16768
  v_exp_f32 v137, v137
  v_exp_f32 v138, v138
  v_exp_f32 v139, v139
  v_exp_f32 v140, v140
  v_exp_f32 v141, v141
  v_exp_f32 v142, v142
  v_exp_f32 v143, v143
  v_cvt_pk_bf16_f32 v152, v128, v129
  v_cvt_pk_bf16_f32 v153, v130, v131
  v_cvt_pk_bf16_f32 v154, v132, v133
  v_cvt_pk_bf16_f32 v155, v134, v135
  v_cvt_pk_bf16_f32 v156, v136, v137
  v_cvt_pk_bf16_f32 v157, v138, v139
  v_cvt_pk_bf16_f32 v158, v140, v141
  v_cvt_pk_bf16_f32 v159, v142, v143
  v_mfma_f32_32x32x16_bf16 v[128:143], v[160:163], v[40:43], 0
  v_exp_f32 v112, v112
  v_exp_f32 v113, v113
  v_exp_f32 v114, v114
  v_mfma_f32_32x32x16_bf16 v[128:143], v[164:167], v[44:47], v[128:143]
  v_exp_f32 v115, v115
  v_exp_f32 v116, v116
  v_exp_f32 v117, v117
  v_mfma_f32_32x32x16_bf16 v[64:79], v[176:179], v[152:155], v[64:79]
  v_exp_f32 v118, v118
  v_exp_f32 v119, v119
  v_exp_f32 v120, v120
  v_mfma_f32_32x32x16_bf16 v[64:79], v[180:183], v[156:159], v[64:79]
  v_exp_f32 v121, v121
  v_exp_f32 v122, v122
  v_exp_f32 v123, v123
  v_exp_f32 v124, v124
  v_exp_f32 v125, v125
  v_exp_f32 v126, v126
  v_exp_f32 v127, v127
  v_cvt_pk_bf16_f32 v144, v112, v113
  v_cvt_pk_bf16_f32 v145, v114, v115
  v_cvt_pk_bf16_f32 v146, v116, v117
  v_cvt_pk_bf16_f32 v147, v118, v119
  v_cvt_pk_bf16_f32 v148, v120, v121
  v_cvt_pk_bf16_f32 v149, v122, v123
  v_cvt_pk_bf16_f32 v150, v124, v125
  v_cvt_pk_bf16_f32 v151, v126, v127
  s_waitcnt lgkmcnt(0)
  v_mfma_f32_32x32x16_bf16 v[112:127], v[168:171], v[16:19], 0
  v_exp_f32 v128, v128
  v_exp_f32 v129, v129
  v_exp_f32 v130, v130
  v_mfma_f32_32x32x16_bf16 v[112:127], v[172:175], v[20:23], v[112:127]
  v_exp_f32 v131, v131
  v_exp_f32 v132, v132
  v_exp_f32 v133, v133
  v_mfma_f32_32x32x16_bf16 v[80:95], v[176:179], v[144:147], v[80:95]
  v_exp_f32 v134, v134
  v_exp_f32 v135, v135
  v_exp_f32 v136, v136
  v_mfma_f32_32x32x16_bf16 v[80:95], v[180:183], v[148:151], v[80:95]
  v_exp_f32 v137, v137
  v_exp_f32 v138, v138
  v_exp_f32 v139, v139
  v_exp_f32 v140, v140
  v_exp_f32 v141, v141
  v_exp_f32 v142, v142
  v_exp_f32 v143, v143
  v_cvt_pk_bf16_f32 v152, v128, v129
  v_cvt_pk_bf16_f32 v153, v130, v131
  v_cvt_pk_bf16_f32 v154, v132, v133
  v_cvt_pk_bf16_f32 v155, v134, v135
  v_cvt_pk_bf16_f32 v156, v136, v137
  v_cvt_pk_bf16_f32 v157, v138, v139
  v_cvt_pk_bf16_f32 v158, v140, v141
  v_cvt_pk_bf16_f32 v159, v142, v143
  v_mfma_f32_32x32x16_bf16 v[128:143], v[168:171], v[24:27], 0
  v_exp_f32 v112, v112
  v_exp_f32 v113, v113
  v_exp_f32 v114, v114
  v_mfma_f32_32x32x16_bf16 v[128:143], v[172:175], v[28:31], v[128:143]
  v_exp_f32 v115, v115
  v_exp_f32 v116, v116
  v_exp_f32 v117, v117
  v_mfma_f32_32x32x16_bf16 v[96:111], v[176:179], v[152:155], v[96:111]
  s_add_u32 m0, s51, 16384
  v_exp_f32 v118, v118
  v_exp_f32 v119, v119
  v_exp_f32 v120, v120
  v_mfma_f32_32x32x16_bf16 v[96:111], v[180:183], v[156:159], v[96:111]
  s_cmp_eq_u32 s45, 3
  s_cbranch_scc1 a_nd1
  s_setprio 3
  buffer_load_dwordx4 v212, s[20:23], s50 offen offset:0 sc1 lds
  buffer_load_dwordx4 v212, s[20:23], s50 offen offset:1024 sc1 lds
  buffer_load_dwordx4 v212, s[20:23], s50 offen offset:2048 sc1 lds
  buffer_load_dwordx4 v212, s[20:23], s50 offen offset:3072 sc1 lds
  s_setprio 1
  s_add_u32 s50, s50, 4096
  s_and_b32 s50, s50, s53
a_ndb1:
  v_exp_f32 v121, v121
  v_exp_f32 v122, v122
  v_exp_f32 v123, v123
  v_exp_f32 v124, v124
  v_exp_f32 v125, v125
  v_exp_f32 v126, v126
  v_exp_f32 v127, v127
  v_cvt_pk_bf16_f32 v144, v112, v113
  v_cvt_pk_bf16_f32 v145, v114, v115
  v_cvt_pk_bf16_f32 v146, v116, v117
  v_cvt_pk_bf16_f32 v147, v118, v119
  v_cvt_pk_bf16_f32 v148, v120, v121
  v_cvt_pk_bf16_f32 v149, v122, v123
  v_cvt_pk_bf16_f32 v150, v124, v125
  v_cvt_pk_bf16_f32 v151, v126, v127
  v_mfma_f32_32x32x16_bf16 v[112:127], v[168:171], v[32:35], 0
  v_exp_f32 v128, v128
  v_exp_f32 v129, v129
  v_exp_f32 v130, v130
  v_mfma_f32_32x32x16_bf16 v[112:127], v[172:175], v[36:39], v[112:127]
  v_exp_f32 v131, v131
  v_exp_f32 v132, v132
  v_exp_f32 v133, v133
  v_mfma_f32_32x32x16_bf16 v[48:63], v[184:187], v[144:147], v[48:63]
  v_exp_f32 v134, v134
  v_exp_f32 v135, v135
  v_exp_f32 v136, v136
  v_mfma_f32_32x32x16_bf16 v[48:63], v[188:191], v[148:151], v[48:63]
  s_waitcnt vmcnt(12)
  ds_read_b128 v[160:163], v5 offset:32768
  ds_read_b128 v[164:167], v5 offset:33792
  ds_read_b64_tr_b16 v[176:177], v6 offset:32768
  ds_read_b64_tr_b16 v[178:179], v6 offset:32896
  ds_read_b64_tr_b16 v[180:181], v6 offset:33024
  ds_read_b64_tr_b16 v[182:183], v6 offset:33152
  v_exp_f32 v137, v137
  v_exp_f32 v138, v138
  v_exp_f32 v139, v139
  v_exp_f32 v140, v140
  v_exp_f32 v141, v141
  v_exp_f32 v142, v142
  v_exp_f32 v143, v143
  v_cvt_pk_bf16_f32 v152, v128, v129
  v_cvt_pk_bf16_f32 v153, v130, v131
  v_cvt_pk_bf16_f32 v154, v132, v133
  v_cvt_pk_bf16_f32 v155, v134, v135
  v_cvt_pk_bf16_f32 v156, v136, v137
  v_cvt_pk_bf16_f32 v157, v138, v139
  v_cvt_pk_bf16_f32 v158, v140, v141
  v_cvt_pk_bf16_f32 v159, v142, v143
  v_mfma_f32_32x32x16_bf16 v[128:143], v[168:171], v[40:43], 0
  v_exp_f32 v112, v112
  v_exp_f32 v113, v113
  v_exp_f32 v114, v114
  v_mfma_f32_32x32x16_bf16 v[128:143], v[172:175], v[44:47], v[128:143]
  v_exp_f32 v115, v115
  v_exp_f32 v116, v116
  v_exp_f32 v117, v117
  v_mfma_f32_32x32x16_bf16 v[64:79], v[184:187], v[152:155], v[64:79]
  v_exp_f32 v118, v118
  v_exp_f32 v119, v119
  v_exp_f32 v120, v120
  v_mfma_f32_32x32x16_bf16 v[64:79], v[188:191], v[156:159], v[64:79]
  v_exp_f32 v121, v121
  v_exp_f32 v122, v122
  v_exp_f32 v123, v123
  v_exp_f32 v124, v124
  v_exp_f32 v125, v125
  v_exp_f32 v126, v126
  v_exp_f32 v127, v127
  v_cvt_pk_bf16_f32 v144, v112, v113
  v_cvt_pk_bf16_f32 v145, v114, v115
  v_cvt_pk_bf16_f32 v146, v116, v117
  v_cvt_pk_bf16_f32 v147, v118, v119
  v_cvt_pk_bf16_f32 v148, v120, v121
  v_cvt_pk_bf16_f32 v149, v122, v123
  v_cvt_pk_bf16_f32 v150, v124, v125
  v_cvt_pk_bf16_f32 v151, v126, v127
  s_waitcnt lgkmcnt(0)
  v_mfma_f32_32x32x16_bf16 v[112:127], v[160:163], v[16:19], 0
  v_exp_f32 v128, v128
  v_exp_f32 v129, v129
  v_exp_f32 v130, v130
  v_mfma_f32_32x32x16_bf16 v[112:127], v[164:167], v[20:23], v[112:127]
  v_exp_f32 v131, v131
  v_exp_f32 v132, v132
  v_exp_f32 v133, v133
  v_mfma_f32_32x32x16_bf16 v[80:95], v[184:187], v[144:147], v[80:95]
  v_exp_f32 v134, v134
  v_exp_f32 v135, v135
  v_exp_f32 v136, v136
  v_mfma_f32_32x32x16_bf16 v[80:95], v[188:191], v[148:151], v[80:95]
  v_exp_f32 v137, v137
  v_exp_f32 v138, v138
  v_exp_f32 v139, v139
  v_exp_f32 v140, v140
  v_exp_f32 v141, v141
  v_exp_f32 v142, v142
  v_exp_f32 v143, v143
  v_cvt_pk_bf16_f32 v152, v128, v129
  v_cvt_pk_bf16_f32 v153, v130, v131
  v_cvt_pk_bf16_f32 v154, v132, v133
  v_cvt_pk_bf16_f32 v155, v134, v135
  v_cvt_pk_bf16_f32 v156, v136, v137
  v_cvt_pk_bf16_f32 v157, v138, v139
  v_cvt_pk_bf16_f32 v158, v140, v141
  v_cvt_pk_bf16_f32 v159, v142, v143
a_loop2:
  v_mfma_f32_32x32x16_bf16 v[128:143], v[160:163], v[24:27], 0
  v_exp_f32 v112, v112
  v_exp_f32 v113, v113
  v_exp_f32 v114, v114
  v_mfma_f32_32x32x16_bf16 v[128:143], v[164:167], v[28:31], v[128:143]
  v_exp_f32 v115, v115
  v_exp_f32 v116, v116
  v_exp_f32 v117, v117
  v_mfma_f32_32x32x16_bf16 v[96:111], v[184:187], v[152:155], v[96:111]
  s_add_u32 m0, s51, 32768
  v_exp_f32 v118, v118
  v_exp_f32 v119, v119
  v_exp_f32 v120, v120
  v_mfma_f32_32x32x16_bf16 v[96:111], v[188:191], v[156:159], v[96:111]
  s_cmp_eq_u32 s45, 3
  s_cbranch_scc1 a_nd2
  s_setprio 3
  buffer_load_dwordx4 v212, s[20:23], s50 offen offset:0 sc1 lds
  buffer_load_dwordx4 v212, s[20:23], s50 offen offset:1024 sc1 lds
  buffer_load_dwordx4 v212, s[20:23], s50 offen offset:2048 sc1 lds
  buffer_load_dwordx4 v212, s[20:23], s50 offen offset:3072 sc1 lds
  s_setprio 1
  s_add_u32 s50, s50, 4096
  s_and_b32 s50, s50, s53
a_ndb2:
  v_exp_f32 v121, v121
  v_exp_f32 v122, v122
  v_exp_f32 v123, v123
  v_exp_f32 v124, v124
  v_exp_f32 v125, v125
  v_exp_f32 v126, v126
  v_exp_f32 v127, v127
  v_cvt_pk_bf16_f32 v144, v112, v113
  v_cvt_pk_bf16_f32 v145, v114, v115
  v_cvt_pk_bf16_f32 v146, v116, v117
  v_cvt_pk_bf16_f32 v147, v118, v119
  v_cvt_pk_bf16_f32 v148, v120, v121
  v_cvt_pk_bf16_f32 v149, v122, v123
  v_cvt_pk_bf16_f32 v150, v124, v125
  v_cvt_pk_bf16_f32 v151, v126, v127
  v_mfma_f32_32x32x16_bf16 v[112:127], v[160:163], v[32:35], 0
  v_exp_f32 v128, v128
  v_exp_f32 v129, v129
  v_exp_f32 v130, v130
  v_mfma_f32_32x32x16_bf16 v[112:127], v[164:167], v[36:39], v[112:127]
  v_exp_f32 v131, v131
  v_exp_f32 v132, v132
  v_exp_f32 v133, v133
  v_mfma_f32_32x32x16_bf16 v[48:63], v[176:179], v[144:147], v[48:63]
  v_exp_f32 v134, v134
  v_exp_f32 v135, v135
  v_exp_f32 v136, v136
  v_mfma_f32_32x32x16_bf16 v[48:63], v[180:183], v[148:151], v[48:63]
  s_waitcnt vmcnt(12)
  ds_read_b128 v[168:171], v5 offset:49152
  ds_read_b128 v[172:175], v5 offset:50176
  ds_read_b64_tr_b16 v[184:185], v6 offset:49152
  ds_read_b64_tr_b16 v[186:187], v6 offset:49280
  ds_read_b64_tr_b16 v[188:189], v6 offset:49408
  ds_read_b64_tr_b16 v[190:191], v6 offset:49536
  v_exp_f32 v137, v137
  v_exp_f32 v138, v138
  v_exp_f32 v139, v139
  v_exp_f32 v140, v140
  v_exp_f32 v141, v141
  v_exp_f32 v142, v142
  v_exp_f32 v143, v143
  v_cvt_pk_bf16_f32 v152, v128, v129
  v_cvt_pk_bf16_f32 v153, v130, v131
  v_cvt_pk_bf16_f32 v154, v132, v133
  v_cvt_pk_bf16_f32 v155, v134, v135
  v_cvt_pk_bf16_f32 v156, v136, v137
  v_cvt_pk_bf16_f32 v157, v138, v139
  v_cvt_pk_bf16_f32 v158, v140, v141
  v_cvt_pk_bf16_f32 v159, v142, v143
  v_mfma_f32_32x32x16_bf16 v[128:143], v[160:163], v[40:43], 0
  v_exp_f32 v112, v112
  v_exp_f32 v113, v113
  v_exp_f32 v114, v114
  v_mfma_f32_32x32x16_bf16 v[128:143], v[164:167], v[44:47], v[128:143]
  v_exp_f32 v115, v115
  v_exp_f32 v116, v116
  v_exp_f32 v117, v117
  v_mfma_f32_32x32x16_bf16 v[64:79], v[176:179], v[152:155], v[64:79]
  v_exp_f32 v118, v118
  v_exp_f32 v119, v119
  v_exp_f32 v120, v120
  v_mfma_f32_32x32x16_bf16 v[64:79], v[180:183], v[156:159], v[64:79]
  v_exp_f32 v121, v121
  v_exp_f32 v122, v122
  v_exp_f32 v123, v123
  v_exp_f32 v124, v124
  v_exp_f32 v125, v125
  v_exp_f32 v126, v126
  v_exp_f32 v127, v127
  v_cvt_pk_bf16_f32 v144, v112, v113
  v_cvt_pk_bf16_f32 v145, v114, v115
  v_cvt_pk_bf16_f32 v146, v116, v117
  v_cvt_pk_bf16_f32 v147, v118, v119
  v_cvt_pk_bf16_f32 v148, v120, v121
  v_cvt_pk_bf16_f32 v149, v122, v123
  v_cvt_pk_bf16_f32 v150, v124, v125
  v_cvt_pk_bf16_f32 v151, v126, v127
  s_waitcnt lgkmcnt(0)
  v_mfma_f32_32x32x16_bf16 v[112:127], v[168:171], v[16:19], 0
  v_exp_f32 v128, v128
  v_exp_f32 v129, v129
  v_exp_f32 v130, v130
  v_mfma_f32_32x32x16_bf16 v[112:127], v[172:175], v[20:23], v[112:127]
  v_exp_f32 v131, v131
  v_exp_f32 v132, v132
  v_exp_f32 v133, v133
  v_mfma_f32_32x32x16_bf16 v[80:95], v[176:179], v[144:147], v[80:95]
  v_exp_f32 v134, v134
  v_exp_f32 v135, v135
  v_exp_f32 v136, v136
  v_mfma_f32_32x32x16_bf16 v[80:95], v[180:183], v[148:151], v[80:95]
  v_exp_f32 v137, v137
  v_exp_f32 v138, v138
  v_exp_f32 v139, v139
  v_exp_f32 v140, v140
  v_exp_f32 v141, v141
  v_exp_f32 v142, v142
  v_exp_f32 v143, v143
  v_cvt_pk_bf16_f32 v152, v128, v129
  v_cvt_pk_bf16_f32 v153, v130, v131
  v_cvt_pk_bf16_f32 v154, v132, v133
  v_cvt_pk_bf16_f32 v155, v134, v135
  v_cvt_pk_bf16_f32 v156, v136, v137
  v_cvt_pk_bf16_f32 v157, v138, v139
  v_cvt_pk_bf16_f32 v158, v140, v141
  v_cvt_pk_bf16_f32 v159, v142, v143
  v_mfma_f32_32x32x16_bf16 v[128:143], v[168:171], v[24:27], 0
  v_exp_f32 v112, v112
  v_exp_f32 v113, v113
  v_exp_f32 v114, v114
  v_mfma_f32_32x32x16_bf16 v[128:143], v[172:175], v[28:31], v[128:143]
  v_exp_f32 v115, v115
  v_exp_f32 v116, v116
  v_exp_f32 v117, v117
  v_mfma_f32_32x32x16_bf16 v[96:111], v[176:179], v[152:155], v[96:111]
  s_add_u32 m0, s51, 49152
  v_exp_f32 v118, v118
  v_exp_f32 v119, v119
  v_exp_f32 v120, v120
  v_mfma_f32_32x32x16_bf16 v[96:111], v[180:183], v[156:159], v[96:111]
  s_cmp_eq_u32 s45, 3
  s_cbranch_scc1 a_nd3
  s_setprio 3
  buffer_load_dwordx4 v212, s[20:23], s50 offen offset:0 sc1 lds
  buffer_load_dwordx4 v212, s[20:23], s50 offen offset:1024 sc1 lds
  buffer_load_dwordx4 v212, s[20:23], s50 offen offset:2048 sc1 lds
  buffer_load_dwordx4 v212, s[20:23], s50 offen offset:3072 sc1 lds
  s_setprio 1
  s_add_u32 s50, s50, 4096
  s_and_b32 s50, s50, s53
a_ndb3:
  v_exp_f32 v121, v121
  v_exp_f32 v122, v122
  v_exp_f32 v123, v123
  v_exp_f32 v124, v124
  v_exp_f32 v125, v125
  v_exp_f32 v126, v126
  v_exp_f32 v127, v127
  v_cvt_pk_bf16_f32 v144, v112, v113
  v_cvt_pk_bf16_f32 v145, v114, v115
  v_cvt_pk_bf16_f32 v146, v116, v117
  v_cvt_pk_bf16_f32 v147, v118, v119
  v_cvt_pk_bf16_f32 v148, v120, v121
  v_cvt_pk_bf16_f32 v149, v122, v123
  v_cvt_pk_bf16_f32 v150, v124, v125
  v_cvt_pk_bf16_f32 v151, v126, v127
  v_mfma_f32_32x32x16_bf16 v[112:127], v[168:171], v[32:35], 0
  v_exp_f32 v128, v128
  v_exp_f32 v129, v129
  v_exp_f32 v130, v130
  v_mfma_f32_32x32x16_bf16 v[112:127], v[172:175], v[36:39], v[112:127]
  v_exp_f32 v131, v131
  v_exp_f32 v132, v132
  v_exp_f32 v133, v133
  v_mfma_f32_32x32x16_bf16 v[48:63], v[184:187], v[144:147], v[48:63]
  v_exp_f32 v134, v134
  v_exp_f32 v135, v135
  v_exp_f32 v136, v136
  v_mfma_f32_32x32x16_bf16 v[48:63], v[188:191], v[148:151], v[48:63]
  s_waitcnt vmcnt(12)
  ds_read_b128 v[160:163], v5 offset:0
  ds_read_b128 v[164:167], v5 offset:1024
  ds_read_b64_tr_b16 v[176:177], v6 offset:0
  ds_read_b64_tr_b16 v[178:179], v6 offset:128
  ds_read_b64_tr_b16 v[180:181], v6 offset:256
  ds_read_b64_tr_b16 v[182:183], v6 offset:384
  v_exp_f32 v137, v137
  v_exp_f32 v138, v138
  v_exp_f32 v139, v139
  v_exp_f32 v140, v140
  v_exp_f32 v141, v141
  v_exp_f32 v142, v142
  v_exp_f32 v143, v143
  v_cvt_pk_bf16_f32 v152, v128, v129
  v_cvt_pk_bf16_f32 v153, v130, v131
  v_cvt_pk_bf16_f32 v154, v132, v133
  v_cvt_pk_bf16_f32 v155, v134, v135
  v_cvt_pk_bf16_f32 v156, v136, v137
  v_cvt_pk_bf16_f32 v157, v138, v139
  v_cvt_pk_bf16_f32 v158, v140, v141
  v_cvt_pk_bf16_f32 v159, v142, v143
  v_mfma_f32_32x32x16_bf16 v[128:143], v[168:171], v[40:43], 0
  v_exp_f32 v112, v112
  v_exp_f32 v113, v113
  v_exp_f32 v114, v114
  v_mfma_f32_32x32x16_bf16 v[128:143], v[172:175], v[44:47], v[128:143]
  v_exp_f32 v115, v115
  v_exp_f32 v116, v116
  v_exp_f32 v117, v117
  v_mfma_f32_32x32x16_bf16 v[64:79], v[184:187], v[152:155], v[64:79]
  v_exp_f32 v118, v118
  v_exp_f32 v119, v119
  v_exp_f32 v120, v120
  v_mfma_f32_32x32x16_bf16 v[64:79], v[188:191], v[156:159], v[64:79]
  v_exp_f32 v121, v121
  v_exp_f32 v122, v122
  v_exp_f32 v123, v123
  v_exp_f32 v124, v124
  v_exp_f32 v125, v125
  v_exp_f32 v126, v126
  v_exp_f32 v127, v127
  v_cvt_pk_bf16_f32 v144, v112, v113
  v_cvt_pk_bf16_f32 v145, v114, v115
  v_cvt_pk_bf16_f32 v146, v116, v117
  v_cvt_pk_bf16_f32 v147, v118, v119
  v_cvt_pk_bf16_f32 v148, v120, v121
  v_cvt_pk_bf16_f32 v149, v122, v123
  v_cvt_pk_bf16_f32 v150, v124, v125
  v_cvt_pk_bf16_f32 v151, v126, v127
  s_waitcnt lgkmcnt(0)
  v_mfma_f32_32x32x16_bf16 v[112:127], v[160:163], v[16:19], 0
  v_exp_f32 v128, v128
  v_exp_f32 v129, v129
  v_exp_f32 v130, v130
  v_mfma_f32_32x32x16_bf16 v[112:127], v[164:167], v[20:23], v[112:127]
  v_exp_f32 v131, v131
  v_exp_f32 v132, v132
  v_exp_f32 v133, v133
  v_mfma_f32_32x32x16_bf16 v[80:95], v[184:187], v[144:147], v[80:95]
  v_exp_f32 v134, v134
  v_exp_f32 v135, v135
  v_exp_f32 v136, v136
  v_mfma_f32_32x32x16_bf16 v[80:95], v[188:191], v[148:151], v[80:95]
  v_exp_f32 v137, v137
  v_exp_f32 v138, v138
  v_exp_f32 v139, v139
  v_exp_f32 v140, v140
  v_exp_f32 v141, v141
  v_exp_f32 v142, v142
  v_exp_f32 v143, v143
  v_cvt_pk_bf16_f32 v152, v128, v129
  v_cvt_pk_bf16_f32 v153, v130, v131
  v_cvt_pk_bf16_f32 v154, v132, v133
  v_cvt_pk_bf16_f32 v155, v134, v135
  v_cvt_pk_bf16_f32 v156, v136, v137
  v_cvt_pk_bf16_f32 v157, v138, v139
  v_cvt_pk_bf16_f32 v158, v140, v141
  v_cvt_pk_bf16_f32 v159, v142, v143
  s_add_u32 s45, s45, 1
  s_cmp_lt_u32 s45, 4
  s_cbranch_scc1 a_loop

a_tail:
  s_setprio 3
  s_nop 1
  v_mfma_f32_32x32x16_bf16 v[96:111], v[184:187], v[152:155], v[96:111]
  v_mfma_f32_32x32x16_bf16 v[96:111], v[188:191], v[156:159], v[96:111]
  s_waitcnt vmcnt(0)
  s_nop 3
  v_add_u32 v12, s51, v2
  ds_write_b128 v12, v[64:67] offset:0
  ds_write_b128 v12, v[68:71] offset:1024
  ds_write_b128 v12, v[72:75] offset:2048
  ds_write_b128 v12, v[76:79] offset:3072
  ds_write_b128 v12, v[80:83] offset:16384
  ds_write_b128 v12, v[84:87] offset:17408
  ds_write_b128 v12, v[88:91] offset:18432
  ds_write_b128 v12, v[92:95] offset:19456
  ds_write_b128 v12, v[96:99] offset:32768
  ds_write_b128 v12, v[100:103] offset:33792
  ds_write_b128 v12, v[104:107] offset:34816
  ds_write_b128 v12, v[108:111] offset:35840
  s_waitcnt lgkmcnt(0)
  v_mov_b32 v12, 1
  ds_write_b32 v9, v12 offset:6176
  s_mov_b32 s78, 4194304
lw_39:
  ds_read_b32 v12, v10 offset:6176
  s_waitcnt lgkmcnt(0)
  v_cmp_gt_u32 vcc, 1, v12
  s_cbranch_vccz lwd_40
  s_sleep 0
  s_sub_u32 s78, s78, 1
  s_cbranch_scc0 lw_39

lwd_40:
  s_xor_b32 s42, s39, 1
  s_lshl_b32 s42, s42, 12
  s_add_u32 s42, s42, 0
  v_add_u32 v12, s42, v2

  ds_read_b128 v[112:115], v12 offset:0
  ds_read_b128 v[116:119], v12 offset:1024
  ds_read_b128 v[120:123], v12 offset:2048
  ds_read_b128 v[124:127], v12 offset:3072
  s_xor_b32 s42, s39, 2
  s_lshl_b32 s42, s42, 12
  s_add_u32 s42, s42, 16384
  v_add_u32 v12, s42, v2

  ds_read_b128 v[128:131], v12 offset:0
  ds_read_b128 v[132:135], v12 offset:1024
  ds_read_b128 v[136:139], v12 offset:2048
  ds_read_b128 v[140:143], v12 offset:3072
  s_xor_b32 s42, s39, 3
  s_lshl_b32 s42, s42, 12
  s_add_u32 s42, s42, 32768
  v_add_u32 v12, s42, v2

  ds_read_b128 v[144:147], v12 offset:0
  ds_read_b128 v[148:151], v12 offset:1024
  ds_read_b128 v[152:155], v12 offset:2048
  ds_read_b128 v[156:159], v12 offset:3072
  s_waitcnt lgkmcnt(11)
  v_add_f32 v48, v48, v112
  v_add_f32 v49, v49, v113
  v_add_f32 v50, v50, v114
  v_add_f32 v51, v51, v115
  s_waitcnt lgkmcnt(10)
  v_add_f32 v52, v52, v116
  v_add_f32 v53, v53, v117
  v_add_f32 v54, v54, v118
  v_add_f32 v55, v55, v119
  s_waitcnt lgkmcnt(9)
  v_add_f32 v56, v56, v120
  v_add_f32 v57, v57, v121
  v_add_f32 v58, v58, v122
  v_add_f32 v59, v59, v123
  s_waitcnt lgkmcnt(8)
  v_add_f32 v60, v60, v124
  v_add_f32 v61, v61, v125
  v_add_f32 v62, v62, v126
  v_add_f32 v63, v63, v127
  s_waitcnt lgkmcnt(7)
  v_add_f32 v48, v48, v128
  v_add_f32 v49, v49, v129
  v_add_f32 v50, v50, v130
  v_add_f32 v51, v51, v131
  s_waitcnt lgkmcnt(6)
  v_add_f32 v52, v52, v132
  v_add_f32 v53, v53, v133
  v_add_f32 v54, v54, v134
  v_add_f32 v55, v55, v135
  s_waitcnt lgkmcnt(5)
  v_add_f32 v56, v56, v136
  v_add_f32 v57, v57, v137
  v_add_f32 v58, v58, v138
  v_add_f32 v59, v59, v139
  s_waitcnt lgkmcnt(4)
  v_add_f32 v60, v60, v140
  v_add_f32 v61, v61, v141
  v_add_f32 v62, v62, v142
  v_add_f32 v63, v63, v143
  s_waitcnt lgkmcnt(3)
  v_add_f32 v48, v48, v144
  v_add_f32 v49, v49, v145
  v_add_f32 v50, v50, v146
  v_add_f32 v51, v51, v147
  s_waitcnt lgkmcnt(2)
  v_add_f32 v52, v52, v148
  v_add_f32 v53, v53, v149
  v_add_f32 v54, v54, v150
  v_add_f32 v55, v55, v151
  s_waitcnt lgkmcnt(1)
  v_add_f32 v56, v56, v152
  v_add_f32 v57, v57, v153
  v_add_f32 v58, v58, v154
  v_add_f32 v59, v59, v155
  s_waitcnt lgkmcnt(0)
  v_add_f32 v60, v60, v156
  v_add_f32 v61, v61, v157
  v_add_f32 v62, v62, v158
  v_add_f32 v63, v63, v159
  s_mov_b32 s52, 0
a_norm:
  v_mov_b32 v12, v60
  v_mov_b32 v13, v60
  s_nop 1
  v_permlane32_swap_b32 v12, v13
  s_nop 1
  v_rcp_f32 v12, v13
  v_mov_b32 v14, 0

  v_mul_f32 v112, v48, v12
  v_mul_f32 v113, v49, v12
  v_mul_f32 v114, v50, v12
  v_mul_f32 v115, v51, v12
  v_mul_f32 v116, v52, v12
  v_mul_f32 v117, v53, v12
  v_mul_f32 v118, v54, v12
  v_mul_f32 v119, v55, v12
  v_mul_f32 v120, v56, v12
  v_mul_f32 v121, v57, v12
  v_mul_f32 v122, v58, v12
  v_mul_f32 v123, v59, v12
  v_mul_f32 v124, v60, v12
  v_mul_f32 v125, v61, v12
  v_mul_f32 v126, v62, v12
  v_mul_f32 v127, v63, v12
  v_fma_f32 v14, v112, 0, v14
  v_fma_f32 v14, v113, 0, v14
  v_fma_f32 v14, v114, 0, v14
  v_fma_f32 v14, v115, 0, v14
  v_fma_f32 v14, v116, 0, v14
  v_fma_f32 v14, v117, 0, v14
  v_fma_f32 v14, v118, 0, v14
  v_fma_f32 v14, v119, 0, v14
  v_fma_f32 v14, v120, 0, v14
  v_fma_f32 v14, v121, 0, v14
  v_fma_f32 v14, v122, 0, v14
  v_fma_f32 v14, v123, 0, v14
  v_fma_f32 v14, v124, 0, v14
  v_fma_f32 v14, v125, 0, v14
  v_fma_f32 v14, v126, 0, v14
  v_fma_f32 v14, v127, 0, v14
  s_mov_b32 s42, 0x12800000
  v_cmp_nle_f32 vcc, s42, v13
  s_mov_b32 s42, 0x71800000
  v_cmp_nge_f32 s[72:73], s42, v13
  v_cmp_u_f32 s[74:75], v14, v14
  s_or_b64 vcc, vcc, s[72:73]
  s_or_b64 vcc, vcc, s[74:75]
  s_cmp_lg_u32 s52, 0
  s_cbranch_scc1 a_store
  s_cbranch_vccnz a_fallback

a_store:
  v_cvt_pk_bf16_f32 v144, v112, v113
  v_cvt_pk_bf16_f32 v145, v114, v115
  v_cvt_pk_bf16_f32 v146, v116, v117
  v_cvt_pk_bf16_f32 v147, v118, v119
  v_cvt_pk_bf16_f32 v148, v120, v121
  v_cvt_pk_bf16_f32 v149, v122, v123
  v_cvt_pk_bf16_f32 v150, v124, v125
  v_cvt_pk_bf16_f32 v151, v126, v127
  v_and_b32 v150, v150, v8
  v_and_b32 v151, v151, v8
  s_lshl_b32 s44, s47, 2
  s_add_u32 s44, s44, s39
  s_mul_i32 s42, s44, 144
  s_lshl_b32 s43, s46, 1
  s_add_u32 s42, s42, s43
  s_lshl_b32 s42, s42, 10
  s_add_u32 s42, s42, 7454720
  buffer_store_dwordx4 v[144:147], v2, s[20:23], s42 offen sc1
  buffer_store_dwordx4 v[148:151], v2, s[20:23], s42 offen offset:1024 sc1
  s_waitcnt vmcnt(0)

  s_lshl_b32 s78, s39, 2
  v_mov_b32 v15, 1
  v_subrev_u32 v14, s78, v9
  ds_add_rtn_u32 v15, v14, v15 offset:6216
  v_mov_b32 v14, s76
  s_waitcnt lgkmcnt(0)
  v_readfirstlane_b32 s78, v15
  v_mov_b32 v15, s77
  s_cmp_lg_u32 s78, 3
  s_cbranch_scc1 pub_41
  buffer_store_dwordx2 v[14:15], v210, s[20:23], 0 offen sc1

pub_41:
  v_mov_b32 v12, 2
  ds_write_b32 v9, v12 offset:6176
  s_endpgm
a_nd0:
  s_waitcnt vmcnt(8)
  s_branch a_ndb0
a_nd1:
  s_waitcnt vmcnt(4)
  s_branch a_ndb1
a_nd2:
  s_waitcnt vmcnt(0)
  s_branch a_ndb2
a_nd3:
  s_waitcnt vmcnt(0)
  s_branch a_ndb3
a_fallback:
  v_and_b32 v22, v22, v8
  v_mov_b32 v12, 0xff800000
  s_mov_b32 s50, s48
  s_mov_b32 s45, 0

a_fb1:
  buffer_load_dwordx4 v[160:163], v2, s[20:23], s50 offen sc1
  buffer_load_dwordx4 v[164:167], v2, s[20:23], s50 offen offset:1024 sc1
  s_waitcnt vmcnt(0)
  v_mfma_f32_32x32x16_bf16 v[112:127], v[160:163], v[16:19], 0
  v_mfma_f32_32x32x16_bf16 v[112:127], v[164:167], v[20:23], v[112:127]
  s_nop 15
  s_nop 3

  v_max3_f32 v12, v12, v112, v113
  v_max3_f32 v12, v12, v114, v115
  v_max3_f32 v12, v12, v116, v117
  v_max3_f32 v12, v12, v118, v119
  v_max3_f32 v12, v12, v120, v121
  v_max3_f32 v12, v12, v122, v123
  v_max3_f32 v12, v12, v124, v125
  v_max3_f32 v12, v12, v126, v127
  s_add_u32 s50, s50, 4096
  s_add_u32 s45, s45, 1
  s_cmp_lt_u32 s45, 64
  s_cbranch_scc1 a_fb1
  v_mov_b32 v13, v12
  s_nop 1
  v_permlane32_swap_b32 v12, v13
  s_nop 1
  v_max_f32 v12, v12, v13

  v_sub_f32 v192, 0, v12
  v_mov_b32 v48, 0
  v_sub_f32 v193, 0, v12
  v_mov_b32 v49, 0
  v_sub_f32 v194, 0, v12
  v_mov_b32 v50, 0
  v_sub_f32 v195, 0, v12
  v_mov_b32 v51, 0
  v_sub_f32 v196, 0, v12
  v_mov_b32 v52, 0
  v_sub_f32 v197, 0, v12
  v_mov_b32 v53, 0
  v_sub_f32 v198, 0, v12
  v_mov_b32 v54, 0
  v_sub_f32 v199, 0, v12
  v_mov_b32 v55, 0
  v_sub_f32 v200, 0, v12
  v_mov_b32 v56, 0
  v_sub_f32 v201, 0, v12
  v_mov_b32 v57, 0
  v_sub_f32 v202, 0, v12
  v_mov_b32 v58, 0
  v_sub_f32 v203, 0, v12
  v_mov_b32 v59, 0
  v_sub_f32 v204, 0, v12
  v_mov_b32 v60, 0
  v_sub_f32 v205, 0, v12
  v_mov_b32 v61, 0
  v_sub_f32 v206, 0, v12
  v_mov_b32 v62, 0
  v_sub_f32 v207, 0, v12
  v_mov_b32 v63, 0
  s_add_u32 m0, s51, 49152
  v_add_u32 v3, 49152, v5
  v_add_u32 v4, 49152, v6
  s_mov_b32 s50, s48
  s_mov_b32 s45, 0

a_fb2:
  buffer_load_dwordx4 v2, s[20:23], s50 offen offset:0 sc1 lds
  buffer_load_dwordx4 v2, s[20:23], s50 offen offset:1024 sc1 lds
  buffer_load_dwordx4 v2, s[20:23], s50 offen offset:2048 sc1 lds
  buffer_load_dwordx4 v2, s[20:23], s50 offen offset:3072 sc1 lds
  s_waitcnt vmcnt(0)
  ds_read_b128 v[160:163], v3 offset:0
  ds_read_b128 v[164:167], v3 offset:1024
  ds_read_b64_tr_b16 v[176:177], v4 offset:0
  ds_read_b64_tr_b16 v[178:179], v4 offset:128
  ds_read_b64_tr_b16 v[180:181], v4 offset:256
  ds_read_b64_tr_b16 v[182:183], v4 offset:384
  s_waitcnt lgkmcnt(0)
  v_mfma_f32_32x32x16_bf16 v[112:127], v[160:163], v[16:19], v[192:207]
  v_mfma_f32_32x32x16_bf16 v[112:127], v[164:167], v[20:23], v[112:127]
  s_nop 15
  s_nop 3

  v_exp_f32 v112, v112
  v_exp_f32 v113, v113
  v_exp_f32 v114, v114
  v_exp_f32 v115, v115
  v_exp_f32 v116, v116
  v_exp_f32 v117, v117
  v_exp_f32 v118, v118
  v_exp_f32 v119, v119
  v_exp_f32 v120, v120
  v_exp_f32 v121, v121
  v_exp_f32 v122, v122
  v_exp_f32 v123, v123
  v_exp_f32 v124, v124
  v_exp_f32 v125, v125
  v_exp_f32 v126, v126
  v_exp_f32 v127, v127
  s_nop 0
  v_cvt_pk_bf16_f32 v144, v112, v113
  v_cvt_pk_bf16_f32 v145, v114, v115
  v_cvt_pk_bf16_f32 v146, v116, v117
  v_cvt_pk_bf16_f32 v147, v118, v119
  v_cvt_pk_bf16_f32 v148, v120, v121
  v_cvt_pk_bf16_f32 v149, v122, v123
  v_cvt_pk_bf16_f32 v150, v124, v125
  v_cvt_pk_bf16_f32 v151, v126, v127
  s_nop 1
  v_mfma_f32_32x32x16_bf16 v[48:63], v[176:179], v[144:147], v[48:63]
  v_mfma_f32_32x32x16_bf16 v[48:63], v[180:183], v[148:151], v[48:63]
  s_add_u32 s50, s50, 4096
  s_add_u32 s45, s45, 1
  s_cmp_lt_u32 s45, 64
  s_cbranch_scc1 a_fb2
  s_nop 15
  s_nop 3
  s_mov_b32 s52, 1
  s_branch a_norm

k_end:
  s_endpgm
.section .rodata,"a"
.p2align 6
.amdhsa_kernel parallel_sum__mha_block__dense_activation_relu__prompt_kernel
  .amdhsa_next_free_vgpr 256
  .amdhsa_next_free_sgpr 100
  .amdhsa_accum_offset 256
  .amdhsa_group_segment_fixed_size 0
  .amdhsa_kernarg_size 72
  .amdhsa_user_sgpr_count 2
  .amdhsa_user_sgpr_kernarg_segment_ptr 1
  .amdhsa_system_sgpr_workgroup_id_x 1
.end_amdhsa_kernel
```
